```python
import torch

def _softmax(x, axis=-1):
    return torch.softmax(x, dim=axis)

def _gelu(x):
    return torch.nn.functional.gelu(x, approximate='tanh')

def _silu(x):
    return torch.nn.functional.silu(x)

def _sigmoid(x):
    return torch.sigmoid(x)

def _layernorm(x, axis=-1, eps=1e-05):
    m = x.mean(dim=axis, keepdim=True)
    v = x.var(dim=axis, keepdim=True, unbiased=False)
    return (x - m) / torch.sqrt(v + eps)

def _scatter_add(tgt, idx, src, axis=0):
    return tgt.clone().index_add_(axis, idx, src)

def _segment_sum(src, seg, n):
    out = torch.zeros((n,) + src.shape[1:], dtype=src.dtype)
    return out.index_add_(0, seg, src)

def _pad(x, pw):
    flat = tuple((v for pair in reversed(pw) for v in pair))
    return torch.nn.functional.pad(x, flat)
kernel_name = 'adaLN_cond__gqa_block_cached__dense_activation_silu__decode'

def setup_inputs():

    _w = lambda a: (lambda t: t.to(torch.bfloat16) if t.is_floating_point() else t)(torch.as_tensor(a))

    def _A_setup():
        B, Sq, D = (1, 1, 576)
        Hq, Hkv, Sk, Dh = (32, 16, 8192, 128)
        assert Hq % Hkv == 0, (Hq, Hkv)
        return {'x': _w((lambda *s: torch.randn(*s, dtype=torch.bfloat16) * 0.1)(B, Sq, D)), 'k_cache': _w((lambda *s: torch.randn(*s, dtype=torch.bfloat16) * 1.6)(B, Hkv, Sk, Dh)), 'v_cache': _w((lambda *s: torch.randn(*s, dtype=torch.bfloat16) * 3.2)(B, Hkv, Sk, Dh)), 'wq': _w((lambda *s: torch.randn(*s, dtype=torch.bfloat16) * 1.6)(D, Hq * Dh) * D ** (-0.5)), 'wo': _w((lambda *s: torch.randn(*s, dtype=torch.bfloat16) * 3.2)(Hq * Dh, D) * (Hq * Dh) ** (-0.5))}
    _A_in = _A_setup()

    def _B_setup():
        B, S, D, F = (1, 1, 576, 4608)
        return {'x': _w((lambda *s: torch.randn(*s, dtype=torch.bfloat16) * 0.1)(B, S, D)), 'w1': _w((lambda *s: torch.randn(*s, dtype=torch.bfloat16) * 3.2)(D, F) * D ** (-0.5)), 'w2': _w((lambda *s: torch.randn(*s, dtype=torch.bfloat16) * 3.2)(F, D) * F ** (-0.5))}
    _B_in = _B_setup()
    return {'A_x': _A_in['x'], 'A_k_cache': _A_in['k_cache'], 'A_v_cache': _A_in['v_cache'], 'A_wq': _A_in['wq'], 'A_wo': _A_in['wo'], 'B_x': _B_in['x'], 'B_w1': _B_in['w1'], 'B_w2': _B_in['w2'], 'c': _w((lambda *s: torch.randn(*s, dtype=torch.bfloat16) * 0.2)(1, 576) * 8.0), 'w_mod': _w((lambda *s: torch.randn(*s, dtype=torch.bfloat16) * 0.2)(576, 6 * 576) * 576 ** (-0.5) * 8.0)}

def reference(A_x, A_k_cache, A_v_cache, A_wq, A_wo, B_x, B_w1, B_w2, c, w_mod):

    def _A_ref(x, k_cache, v_cache, wq, wo):
        B, Sq, D = x.shape
        Hq, Dh = (32, 128)
        Hkv = k_cache.shape[1]
        rep = Hq // Hkv
        q = (lambda x, *d: x.permute(*d))((x @ wq).reshape(B, Sq, Hq, Dh), 0, 2, 1, 3)
        k = (lambda x, n, axis: torch.repeat_interleave(x, n, dim=axis))(k_cache, rep, axis=1)
        v = (lambda x, n, axis: torch.repeat_interleave(x, n, dim=axis))(v_cache, rep, axis=1)
        scores = torch.einsum('bhqd,bhkd->bhqk', q, k) * Dh ** (-0.5)
        p = _softmax(scores, axis=-1)
        o = torch.einsum('bhqk,bhkd->bhqd', p, v)
        return (lambda x, *d: x.permute(*d))(o, 0, 2, 1, 3).reshape(B, Sq, Hq * Dh) @ wo

    def _B_ref(x, w1, w2):
        h = torch.einsum('bsd,df->bsf', x, w1)
        h = _silu(h)
        out = torch.einsum('bsf,fd->bsd', h, w2)
        return out
    x = A_x
    mod = (_silu(c) @ w_mod).reshape(c.shape[0], 6, 1, -1)
    sa, ca, ga, sb, cb, gb = (mod[:, 0].clone(), mod[:, 1].clone(), mod[:, 2].clone(), mod[:, 3].clone(), mod[:, 4].clone(), mod[:, 5].clone())
    h = _layernorm(x, axis=-1) * (1 + ca) + sa
    x = x + ga * _A_ref(h, A_k_cache, A_v_cache, A_wq, A_wo)
    h = _layernorm(x, axis=-1) * (1 + cb) + sb
    x = x + gb * _B_ref(h, B_w1, B_w2)
    return x
```

```asm
; @launch grid=(256,1,1) block=(768,1,1) lds=26624
.amdgcn_target "amdgcn-amd-amdhsa--gfx950"
.text
.globl adaLN_cond__gqa_block_cached__dense_activation_silu__decode_kernel
.p2align 8
.type adaLN_cond__gqa_block_cached__dense_activation_silu__decode_kernel,@function
adaLN_cond__gqa_block_cached__dense_activation_silu__decode_kernel:
    s_cmp_ge_u32 s2, 256
    s_cbranch_scc1 L_exit
    s_load_dwordx16 s[16:31], s[0:1], 0
    s_load_dwordx8 s[32:39], s[0:1], 64
    s_load_dwordx2 s[40:41], s[0:1], 96
    s_getpc_b64 s[64:65]
L_pc:
    s_sub_u32 s48, s64, (L_pc - adaLN_cond__gqa_block_cached__dense_activation_silu__decode_kernel)
    s_subb_u32 s49, s65, 0
    s_mov_b32 s50, (L_code_end - adaLN_cond__gqa_block_cached__dense_activation_silu__decode_kernel)
    s_mov_b32 s51, 0x20000
    v_lshlrev_b32 v2, 7, v0
    buffer_load_dword v167, v2, s[48:51], 0 offen
    v_lshrrev_b32 v2, 6, v0
    v_and_b32 v1, 63, v0
    v_readfirstlane_b32 s3, v2
    s_and_b32 s6, s2, 7
    s_mov_b32 s94, s3
    s_lshr_b32 s7, s2, 3
    s_lshl_b32 s4, s6, 1
    s_lshr_b32 s8, s7, 4
    s_add_u32 s4, s4, s8
    s_and_b32 s5, s7, 15
    s_lshl_b32 s59, s4, 4
    s_add_u32 s59, s59, s5
    s_mul_i32 s58, s4, 9
    s_add_u32 s58, s58, s5
    s_sub_u32 s58, s58, 7
    s_mov_b32 s56, 0x3db504f3
    s_mov_b32 s57, 0x3fb8aa3b
    v_mov_b32 v3, 0
    s_waitcnt lgkmcnt(0)
    s_mov_b32 s44, s40
    s_mov_b32 s45, s41
    s_mov_b32 s46, 16777216
    s_mov_b32 s47, 0x20000
    s_cmp_ge_u32 s3, 8
    s_cbranch_scc1 L_chain
    s_load_dword s42, s[40:41], 0
    s_lshl_b32 s6, s4, 21
    s_lshl_b32 s7, s5, 17
    s_add_u32 s6, s6, s7
    s_lshl_b32 s7, s3, 14
    s_add_u32 s6, s6, s7
    s_add_u32 s48, s18, s6
    s_addc_u32 s49, s19, 0
    s_mov_b32 s50, 16384
    s_mov_b32 s51, 0x20000
    s_add_u32 s52, s20, s6
    s_addc_u32 s53, s21, 0
    s_mov_b32 s54, 16384
    s_mov_b32 s55, 0x20000
    v_lshrrev_b32 v8, 4, v1
    v_bfe_u32 v9, v1, 2, 2
    v_and_b32 v10, 3, v1
    v_lshlrev_b32 v8, 6, v8
    v_lshlrev_b32 v9, 8, v9
    v_lshlrev_b32 v10, 4, v10
    v_add3_u32 v36, v8, v9, v10
    v_lshlrev_b32 v37, 4, v1
    s_mov_b32 s61, 4096
    s_mov_b32 s62, 8192
    s_mov_b32 s63, 12288
    s_mov_b32 s71, 0
    s_barrier
    s_sleep 40
    buffer_load_dwordx4 v[40:43], v36, s[48:51], 0 offen offset:0 nt
    buffer_load_dwordx4 v[44:47], v36, s[48:51], 0 offen offset:1024 nt
    buffer_load_dwordx4 v[48:51], v36, s[48:51], 0 offen offset:2048 nt
    v_and_b32 v8, 1, v1
    v_lshlrev_b32 v8, 4, v8
    v_mov_b32 v4, 0xffff
    v_lshlrev_b32 v7, v8, v4
    v_bfe_u32 v8, v1, 1, 2
    v_cmp_eq_u32 vcc, 0, v8
    s_nop 1
    v_cndmask_b32 v4, 0, v7, vcc
    v_cmp_eq_u32 vcc, 1, v8
    s_nop 1
    v_cndmask_b32 v5, 0, v7, vcc
    v_cmp_eq_u32 vcc, 2, v8
    s_nop 1
    v_cndmask_b32 v6, 0, v7, vcc
    v_cmp_eq_u32 vcc, 3, v8
    s_nop 1
    v_cndmask_b32 v7, 0, v7, vcc
    v_bfe_u32 v16, v1, 3, 1
    v_lshlrev_b32 v38, 5, v16
    s_lshl_b32 s6, s3, 2
    v_add_u32 v39, s6, v38
    v_lshlrev_b32 v16, 8, v16
    v_lshrrev_b32 v17, 4, v1
    v_lshlrev_b32 v17, 6, v17
    v_and_b32 v18, 3, v1
    v_lshlrev_b32 v18, 4, v18
    v_add3_u32 v0, v16, v17, v18
    v_lshrrev_b32 v8, 5, v1
    v_lshlrev_b32 v8, 12, v8
    v_and_b32 v9, 31, v1
    v_lshlrev_b32 v9, 2, v9
    s_lshl_b32 s6, s3, 7
    v_add3_u32 v2, v8, v9, s6
    s_lshl_b32 s8, s59, 10
    s_add_u32 s8, s8, 131072
    s_mov_b32 s66, 0xf0f0f0f0
    s_mov_b32 s67, 0xf0f0f0f0
    s_waitcnt vmcnt(2)
    buffer_load_dwordx4 v[52:55], v36, s[48:51], 0 offen offset:3072 nt
    s_waitcnt vmcnt(2)
    buffer_load_dwordx4 v[56:59], v36, s[48:51], s61 offen offset:0 nt
    s_waitcnt vmcnt(2)
    buffer_load_dwordx4 v[60:63], v36, s[48:51], s61 offen offset:1024 nt
    s_waitcnt vmcnt(2)
    buffer_load_dwordx4 v[64:67], v36, s[48:51], s61 offen offset:2048 nt
    s_waitcnt vmcnt(2)
    buffer_load_dwordx4 v[68:71], v36, s[48:51], s61 offen offset:3072 nt
    s_waitcnt vmcnt(2)
    buffer_load_dwordx4 v[72:75], v36, s[48:51], s62 offen offset:0 nt
    s_waitcnt vmcnt(2)
    buffer_load_dwordx4 v[76:79], v36, s[48:51], s62 offen offset:1024 nt
    s_waitcnt vmcnt(2)
    buffer_load_dwordx4 v[80:83], v36, s[48:51], s62 offen offset:2048 nt
    s_waitcnt vmcnt(2)
    buffer_load_dwordx4 v[84:87], v36, s[48:51], s62 offen offset:3072 nt
    s_waitcnt vmcnt(2)
    buffer_load_dwordx4 v[88:91], v36, s[48:51], s63 offen offset:0 nt
    s_waitcnt vmcnt(2)
    buffer_load_dwordx4 v[92:95], v36, s[48:51], s63 offen offset:1024 nt
    s_waitcnt vmcnt(2)
    buffer_load_dwordx4 v[96:99], v36, s[48:51], s63 offen offset:2048 nt
    s_waitcnt vmcnt(2)
    buffer_load_dwordx4 v[100:103], v36, s[48:51], s63 offen offset:3072 nt
    v_lshrrev_b32 v8, 5, v1
    v_lshlrev_b32 v8, 9, v8
    v_and_b32 v9, 15, v1
    v_lshl_add_u32 v8, v9, 5, v8
    v_bfe_u32 v9, v1, 4, 1
    v_lshl_add_u32 v8, v9, 4, v8
    s_lshl_b32 s6, s3, 10
    v_add_u32 v36, s6, v8
    s_waitcnt lgkmcnt(0)
    s_add_u32 s42, s42, 1
    s_waitcnt vmcnt(2)
    buffer_load_dwordx4 v[104:107], v37, s[52:55], 0 offen offset:0 nt
    s_waitcnt vmcnt(2)
    buffer_load_dwordx4 v[108:111], v37, s[52:55], 0 offen offset:1024 nt
    s_waitcnt vmcnt(2)
    buffer_load_dwordx4 v[112:115], v37, s[52:55], 0 offen offset:2048 nt
    s_waitcnt vmcnt(2)
    buffer_load_dwordx4 v[116:119], v37, s[52:55], 0 offen offset:3072 nt
    s_cmp_lg_u32 s71, 0
    s_cbranch_scc1 L_ck4_skip
    v_mov_b32 v16, 708
    s_mov_b32 s43, 0
L_ck4:
    ds_read_b32 v17, v16
    s_waitcnt lgkmcnt(0)
    v_readfirstlane_b32 s72, v17
    s_nop 0
    s_cmp_lg_u32 s72, 0
    s_cbranch_scc1 L_ck4_go
    s_branch L_ck4_skip
L_ck4_go:
    s_waitcnt vmcnt(4)
    s_call_b64 s[74:75], L_qk
L_ck4_skip:
    s_waitcnt vmcnt(2)
    buffer_load_dwordx4 v[120:123], v37, s[52:55], s61 offen offset:0 nt
    s_waitcnt vmcnt(2)
    buffer_load_dwordx4 v[124:127], v37, s[52:55], s61 offen offset:1024 nt
    s_waitcnt vmcnt(2)
    buffer_load_dwordx4 v[128:131], v37, s[52:55], s61 offen offset:2048 nt
    s_cmp_lg_u32 s71, 0
    s_cbranch_scc1 L_ck7_skip
    v_mov_b32 v16, 708
    s_mov_b32 s43, 0
L_ck7:
    ds_read_b32 v17, v16
    s_waitcnt lgkmcnt(0)
    v_readfirstlane_b32 s72, v17
    s_nop 0
    s_cmp_lg_u32 s72, 0
    s_cbranch_scc1 L_ck7_go
    s_branch L_ck7_skip
L_ck7_go:
    s_waitcnt vmcnt(7)
    s_call_b64 s[74:75], L_qk
L_ck7_skip:
    s_waitcnt vmcnt(2)
    buffer_load_dwordx4 v[132:135], v37, s[52:55], s61 offen offset:3072 nt
    v_mov_b32 v16, 728
    v_mov_b32 v17, 1
    s_mov_b64 exec, 1
    ds_add_u32 v16, v17
    s_mov_b64 exec, -1
    s_waitcnt vmcnt(2)
    buffer_load_dwordx4 v[136:139], v37, s[52:55], s62 offen offset:0 nt
    s_waitcnt vmcnt(2)
    buffer_load_dwordx4 v[140:143], v37, s[52:55], s62 offen offset:1024 nt
    s_cmp_lg_u32 s71, 0
    s_cbranch_scc1 L_ck10_skip
    v_mov_b32 v16, 708
    s_mov_b32 s43, 0
L_ck10:
    ds_read_b32 v17, v16
    s_waitcnt lgkmcnt(0)
    v_readfirstlane_b32 s72, v17
    s_nop 0
    s_cmp_lg_u32 s72, 0
    s_cbranch_scc1 L_ck10_go
    s_branch L_ck10_skip
L_ck10_go:
    s_waitcnt vmcnt(10)
    s_call_b64 s[74:75], L_qk
L_ck10_skip:
    s_waitcnt vmcnt(2)
    buffer_load_dwordx4 v[144:147], v37, s[52:55], s62 offen offset:2048 nt
    s_waitcnt vmcnt(2)
    buffer_load_dwordx4 v[148:151], v37, s[52:55], s62 offen offset:3072 nt
    s_waitcnt vmcnt(2)
    buffer_load_dwordx4 v[152:155], v37, s[52:55], s63 offen offset:0 nt
    s_cmp_lg_u32 s71, 0
    s_cbranch_scc1 L_ck13_skip
    v_mov_b32 v16, 708
    s_mov_b32 s43, 0
L_ck13:
    ds_read_b32 v17, v16
    s_waitcnt lgkmcnt(0)
    v_readfirstlane_b32 s72, v17
    s_nop 0
    s_cmp_lg_u32 s72, 0
    s_cbranch_scc1 L_ck13_go
    s_branch L_ck13_skip
L_ck13_go:
    s_waitcnt vmcnt(13)
    s_call_b64 s[74:75], L_qk
L_ck13_skip:
    s_waitcnt vmcnt(2)
    buffer_load_dwordx4 v[156:159], v37, s[52:55], s63 offen offset:1024 nt
    s_waitcnt vmcnt(2)
    buffer_load_dwordx4 v[160:163], v37, s[52:55], s63 offen offset:2048 nt
    s_waitcnt vmcnt(2)
    buffer_load_dwordx4 v[164:167], v37, s[52:55], s63 offen offset:3072 nt
    v_mov_b32 v16, 720
    v_mov_b32 v17, 1
    s_mov_b64 exec, 1
    ds_add_u32 v16, v17
    s_mov_b64 exec, -1
    s_cmp_lg_u32 s71, 0
    s_cbranch_scc1 L_ck16_skip
    v_mov_b32 v16, 708
    s_mov_b32 s43, 0
L_ck16:
    ds_read_b32 v17, v16
    s_waitcnt lgkmcnt(0)
    v_readfirstlane_b32 s72, v17
    s_nop 0
    s_cmp_lg_u32 s72, 0
    s_cbranch_scc1 L_ck16_go
    s_add_u32 s43, s43, 1
    s_cmp_lt_u32 s43, 1600000
    s_cbranch_scc0 L_ck16_go
    s_sleep 1
    s_branch L_ck16
L_ck16_go:
    s_waitcnt vmcnt(16)
    s_call_b64 s[74:75], L_qk
L_ck16_skip:
    v_and_b32 v16, v20, v4
    v_and_b32 v17, v20, v5
    v_and_b32 v18, v28, v6
    v_and_b32 v19, v28, v7
    s_nop 1
    v_mfma_f32_16x16x32_bf16 v[12:15], v[16:19], v[104:107], 0
    v_and_b32 v8, v28, v4
    v_and_b32 v9, v28, v5
    v_and_b32 v10, v20, v6
    v_and_b32 v11, v20, v7
    s_nop 1
    v_mfma_f32_16x16x32_bf16 v[12:15], v[8:11], v[108:111], v[12:15]
    v_and_b32 v16, v21, v4
    v_and_b32 v17, v21, v5
    v_and_b32 v18, v29, v6
    v_and_b32 v19, v29, v7
    s_nop 1
    v_mfma_f32_16x16x32_bf16 v[12:15], v[16:19], v[112:115], v[12:15]
    v_and_b32 v8, v29, v4
    v_and_b32 v9, v29, v5
    v_and_b32 v10, v21, v6
    v_and_b32 v11, v21, v7
    s_nop 1
    v_mfma_f32_16x16x32_bf16 v[12:15], v[8:11], v[116:119], v[12:15]
    v_and_b32 v16, v22, v4
    v_and_b32 v17, v22, v5
    v_and_b32 v18, v30, v6
    v_and_b32 v19, v30, v7
    s_nop 1
    v_mfma_f32_16x16x32_bf16 v[12:15], v[16:19], v[120:123], v[12:15]
    v_and_b32 v8, v30, v4
    v_and_b32 v9, v30, v5
    v_and_b32 v10, v22, v6
    v_and_b32 v11, v22, v7
    s_nop 1
    v_mfma_f32_16x16x32_bf16 v[12:15], v[8:11], v[124:127], v[12:15]
    v_and_b32 v16, v23, v4
    v_and_b32 v17, v23, v5
    v_and_b32 v18, v31, v6
    v_and_b32 v19, v31, v7
    s_nop 1
    v_mfma_f32_16x16x32_bf16 v[12:15], v[16:19], v[128:131], v[12:15]
    v_and_b32 v8, v31, v4
    v_and_b32 v9, v31, v5
    v_and_b32 v10, v23, v6
    v_and_b32 v11, v23, v7
    s_nop 1
    v_mfma_f32_16x16x32_bf16 v[12:15], v[8:11], v[132:135], v[12:15]
    v_and_b32 v16, v24, v4
    v_and_b32 v17, v24, v5
    v_and_b32 v18, v32, v6
    v_and_b32 v19, v32, v7
    s_nop 1
    v_mfma_f32_16x16x32_bf16 v[12:15], v[16:19], v[136:139], v[12:15]
    v_and_b32 v8, v32, v4
    v_and_b32 v9, v32, v5
    v_and_b32 v10, v24, v6
    v_and_b32 v11, v24, v7
    s_nop 1
    v_mfma_f32_16x16x32_bf16 v[12:15], v[8:11], v[140:143], v[12:15]
    v_and_b32 v16, v25, v4
    v_and_b32 v17, v25, v5
    v_and_b32 v18, v33, v6
    v_and_b32 v19, v33, v7
    s_nop 1
    v_mfma_f32_16x16x32_bf16 v[12:15], v[16:19], v[144:147], v[12:15]
    v_and_b32 v8, v33, v4
    v_and_b32 v9, v33, v5
    v_and_b32 v10, v25, v6
    v_and_b32 v11, v25, v7
    s_nop 1
    v_mfma_f32_16x16x32_bf16 v[12:15], v[8:11], v[148:151], v[12:15]
    v_and_b32 v16, v26, v4
    v_and_b32 v17, v26, v5
    v_and_b32 v18, v34, v6
    v_and_b32 v19, v34, v7
    s_nop 1
    v_mfma_f32_16x16x32_bf16 v[12:15], v[16:19], v[152:155], v[12:15]
    v_and_b32 v8, v34, v4
    v_and_b32 v9, v34, v5
    v_and_b32 v10, v26, v6
    v_and_b32 v11, v26, v7
    s_waitcnt vmcnt(2)
    s_nop 0
    v_mfma_f32_16x16x32_bf16 v[12:15], v[8:11], v[156:159], v[12:15]
    v_and_b32 v16, v27, v4
    v_and_b32 v17, v27, v5
    v_and_b32 v18, v35, v6
    v_and_b32 v19, v35, v7
    s_waitcnt vmcnt(1)
    s_nop 0
    v_mfma_f32_16x16x32_bf16 v[12:15], v[16:19], v[160:163], v[12:15]
    v_and_b32 v8, v35, v4
    v_and_b32 v9, v35, v5
    v_and_b32 v10, v27, v6
    v_and_b32 v11, v27, v7
    s_waitcnt vmcnt(0)
    s_nop 0
    v_mfma_f32_16x16x32_bf16 v[12:15], v[8:11], v[164:167], v[12:15]
    s_lshr_b32 s6, s3, 2
    s_lshl_b32 s6, s6, 5
    v_lshrrev_b32 v0, 5, v1
    v_lshlrev_b32 v0, 4, v0
    v_add_u32 v0, s6, v0
    v_xor_b32 v37, 16, v0
    v_mov_b32 v16, 712
    v_mov_b32 v17, 1
    ds_write_b128 v36, v[12:15] offset:8192
    s_mov_b64 exec, 1
    ds_add_u32 v16, v17
    s_mov_b64 exec, -1
    s_mov_b32 s43, 0
L_sbar:
    ds_read_b32 v17, v16
    s_add_u32 s43, s43, 1
    s_cmp_lt_u32 s43, 1600000
    s_cbranch_scc0 L_sbar_done
    s_waitcnt lgkmcnt(0)
    v_cmp_ne_u32 vcc, 8, v17
    s_cbranch_vccnz L_sbar
L_sbar_done:
    s_waitcnt lgkmcnt(0)
    ds_read_b128 v[8:11], v0 offset:512
    ds_read_b128 v[12:15], v37 offset:512
    ds_read_b32 v16, v2 offset:8192
    ds_read_b32 v17, v2 offset:9216
    ds_read_b32 v18, v2 offset:10240
    ds_read_b32 v19, v2 offset:11264
    s_waitcnt lgkmcnt(4)
    v_max3_f32 v12, v12, v13, v14
    v_max3_f32 v20, v8, v9, v10
    v_max3_f32 v12, v12, v15, v11
    v_max_f32 v12, v12, v20
    v_sub_f32 v8, v8, v12
    v_sub_f32 v9, v9, v12
    v_sub_f32 v10, v10, v12
    v_sub_f32 v11, v11, v12
    v_mul_f32 v8, s57, v8
    v_mul_f32 v9, s57, v9
    v_mul_f32 v10, s57, v10
    v_mul_f32 v11, s57, v11
    v_exp_f32 v8, v8
    v_exp_f32 v9, v9
    v_exp_f32 v10, v10
    v_exp_f32 v11, v11
    s_waitcnt lgkmcnt(0)
    v_mul_f32 v16, v16, v8
    v_mul_f32 v18, v18, v10
    v_fmac_f32 v16, v17, v9
    v_fmac_f32 v18, v19, v11
    v_add_f32 v16, v16, v18
    v_mov_b32 v17, v16
    s_nop 1
    v_permlane32_swap_b32 v16, v17
    v_add_f32 v16, v16, v17
    s_nop 1
    v_mov_b32_dpp v20, v16 quad_perm:[0,0,0,0] row_mask:0xf bank_mask:0xf
    v_mov_b32_dpp v21, v16 quad_perm:[1,1,1,1] row_mask:0xf bank_mask:0xf
    v_mov_b32_dpp v22, v16 quad_perm:[2,2,2,2] row_mask:0xf bank_mask:0xf
    v_mov_b32_dpp v23, v16 quad_perm:[3,3,3,3] row_mask:0xf bank_mask:0xf
    s_mov_b32 exec_lo, 0x11111111
    s_mov_b32 exec_hi, 0
    buffer_store_dwordx4 v[20:23], v2, s[44:47], s8 offen sc1
    s_mov_b64 exec, -1
    v_mov_b32 v16, 724
    s_mov_b32 s43, 0
L_s_role:
    ds_read_b32 v17, v16
    s_add_u32 s43, s43, 1
    s_cmp_lt_u32 s43, 1600000
    s_cbranch_scc0 L_s_role_done
    s_waitcnt lgkmcnt(0)
    v_readfirstlane_b32 s70, v17
    s_nop 0
    s_cmp_eq_u32 s70, 0
    s_cbranch_scc1 L_s_role
L_s_role_done:
    s_waitcnt lgkmcnt(0)
    s_mov_b32 s71, 0
    s_sub_u32 s6, s70, 10
    s_cmp_ge_u32 s6, 18
    s_cbranch_scc1 L_s_sig
    s_cmp_ge_u32 s3, 4
    s_cbranch_scc1 L_s_sig
    s_mov_b32 s71, 1
    s_mov_b32 s52, s16
    s_mov_b32 s53, s17
    s_mov_b32 s54, 1152
    s_mov_b32 s55, 0x20000
    s_mul_i32 s6, s3, 288
    v_lshlrev_b32 v8, 3, v1
    buffer_load_dwordx2 v[40:41], v8, s[52:55], s6 offen
L_s_sig:
    v_mov_b32 v16, 716
    v_mov_b32 v17, 1
    s_mov_b64 exec, 1
    ds_add_u32 v16, v17
    s_mov_b64 exec, -1
    s_cmp_eq_u32 s71, 1
    s_cbranch_scc1 L_s_ffn
    s_endpgm
L_s_ffn:
    s_mov_b32 s43, 0
    v_mov_b32 v14, 740
L_sc_w:
    ds_read_b32 v15, v14
    s_add_u32 s43, s43, 1
    s_cmp_lt_u32 s43, 1600000
    s_cbranch_scc0 L_sc_w_done
    s_waitcnt lgkmcnt(0)
    v_cmp_ne_u32 vcc, 4, v15
    s_cbranch_vccz L_sc_w_done
    s_sleep 1
    s_branch L_sc_w
L_sc_w_done:
    s_waitcnt lgkmcnt(0)
    s_mul_i32 s6, s3, 576
    v_lshlrev_b32 v8, 4, v1
    v_add_u32 v8, s6, v8
    ds_read_b128 v[24:27], v8 offset:16384
    ds_read_b128 v[28:31], v8 offset:18688
    ds_read_b128 v[32:35], v8 offset:20992
    s_waitcnt vmcnt(0) lgkmcnt(0)
    v_lshlrev_b32 v36, 16, v40
    v_and_b32 v37, 0xffff0000, v40
    v_lshlrev_b32 v38, 16, v41
    v_and_b32 v39, 0xffff0000, v41
    v_lshlrev_b32 v9, 4, v1
    s_mul_i32 s7, s3, 576
    v_add_u32 v8, s7, v9
    s_add_u32 s7, s7, 458752
    s_lshl_b32 s6, s3, 4
    v_mov_b32 v10, s6
    v_mov_b32 v11, 0
    s_mov_b32 s43, 0
    v_mov_b32 v14, 736
L_h2_ww:
    ds_read_b32 v15, v14
    s_add_u32 s43, s43, 1
    s_cmp_lt_u32 s43, 1600000
    s_cbranch_scc0 L_h2_ww_done
    s_waitcnt lgkmcnt(0)
    v_cmp_ne_u32 vcc, 4, v15
    s_cbranch_vccz L_h2_ww_done
    s_sleep 1
    s_branch L_h2_ww
L_h2_ww_done:
    s_waitcnt lgkmcnt(0)
    s_mov_b32 exec_lo, 0xffffffff
    s_mov_b32 exec_hi, 0xf
    s_mov_b32 s43, 0
L_h2:
    s_mov_b32 s6, s7
    buffer_load_dwordx4 v[40:43], v9, s[44:47], s6 offen sc1
    s_add_u32 s6, s6, 2304
    buffer_load_dwordx4 v[44:47], v9, s[44:47], s6 offen sc1
    s_add_u32 s6, s6, 2304
    buffer_load_dwordx4 v[48:51], v9, s[44:47], s6 offen sc1
    s_add_u32 s6, s6, 2304
    buffer_load_dwordx4 v[52:55], v9, s[44:47], s6 offen sc1
    s_add_u32 s6, s6, 2304
    buffer_load_dwordx4 v[56:59], v9, s[44:47], s6 offen sc1
    s_add_u32 s6, s6, 2304
    buffer_load_dwordx4 v[60:63], v9, s[44:47], s6 offen sc1
    s_add_u32 s6, s6, 2304
    buffer_load_dwordx4 v[64:67], v9, s[44:47], s6 offen sc1
    s_add_u32 s6, s6, 2304
    buffer_load_dwordx4 v[68:71], v9, s[44:47], s6 offen sc1
    s_waitcnt vmcnt(0)
    v_add_f32 v40, v40, v56
    v_add_f32 v41, v41, v57
    v_add_f32 v42, v42, v58
    v_add_f32 v43, v43, v59
    v_add_f32 v44, v44, v60
    v_add_f32 v45, v45, v61
    v_add_f32 v46, v46, v62
    v_add_f32 v47, v47, v63
    v_add_f32 v48, v48, v64
    v_add_f32 v49, v49, v65
    v_add_f32 v50, v50, v66
    v_add_f32 v51, v51, v67
    v_add_f32 v52, v52, v68
    v_add_f32 v53, v53, v69
    v_add_f32 v54, v54, v70
    v_add_f32 v55, v55, v71
    v_add_f32 v40, v40, v48
    v_add_f32 v41, v41, v49
    v_add_f32 v42, v42, v50
    v_add_f32 v43, v43, v51
    v_add_f32 v44, v44, v52
    v_add_f32 v45, v45, v53
    v_add_f32 v46, v46, v54
    v_add_f32 v47, v47, v55
    v_add_f32 v20, v40, v44
    v_add_f32 v21, v41, v45
    v_add_f32 v22, v42, v46
    v_add_f32 v23, v43, v47
    v_add_f32 v12, v20, v21
    v_add_f32 v13, v22, v23
    v_add_f32 v12, v12, v13
    v_cmp_u_f32 vcc, v12, v12
    s_cbranch_vccz L_h2_done
    s_add_u32 s43, s43, 1
    s_cmp_lt_u32 s43, 200000
    s_cbranch_scc0 L_h2_done
    s_branch L_h2
L_h2_done:
    v_mov_b32 v14, 748
    v_mov_b32 v15, 1
    s_mov_b64 exec, 1
    ds_add_u32 v14, v15
    s_mov_b32 exec_lo, 0xffffffff
    s_mov_b32 exec_hi, 0xf
    v_cvt_pk_bf16_f32 v12, v20, v21
    v_cvt_pk_bf16_f32 v13, v22, v23
    v_lshlrev_b32 v20, 16, v12
    v_and_b32 v21, 0xffff0000, v12
    v_lshlrev_b32 v22, 16, v13
    v_and_b32 v23, 0xffff0000, v13
    v_mul_f32 v20, v20, v24
    v_mul_f32 v21, v21, v25
    v_mul_f32 v22, v22, v26
    v_mul_f32 v23, v23, v27
    v_cvt_pk_bf16_f32 v12, v20, v21
    v_cvt_pk_bf16_f32 v13, v22, v23
    v_lshlrev_b32 v20, 16, v12
    v_and_b32 v21, 0xffff0000, v12
    v_lshlrev_b32 v22, 16, v13
    v_and_b32 v23, 0xffff0000, v13
    v_add_f32 v20, v20, v36
    v_add_f32 v21, v21, v37
    v_add_f32 v22, v22, v38
    v_add_f32 v23, v23, v39
    v_cvt_pk_bf16_f32 v12, v20, v21
    v_cvt_pk_bf16_f32 v13, v22, v23
    v_lshlrev_b32 v20, 16, v12
    v_and_b32 v21, 0xffff0000, v12
    v_lshlrev_b32 v22, 16, v13
    v_and_b32 v23, 0xffff0000, v13
    v_readfirstlane_b32 s64, v20
    s_mov_b64 exec, -1
    v_mov_b32 v16, 0
    v_mov_b32 v17, 0
    s_mov_b32 exec_lo, 0xffffffff
    s_mov_b32 exec_hi, 0xf
    v_subrev_f32 v12, s64, v20
    v_subrev_f32 v13, s64, v21
    v_subrev_f32 v14, s64, v22
    v_subrev_f32 v15, s64, v23
    v_add_f32 v16, v12, v13
    v_mul_f32 v17, v12, v12
    v_add_f32 v18, v14, v15
    v_fmac_f32 v17, v13, v13
    v_add_f32 v16, v16, v18
    v_fmac_f32 v17, v14, v14
    v_fmac_f32 v17, v15, v15
    s_mov_b64 exec, -1
    v_add_f32_dpp v16, v16, v16 row_ror:8 row_mask:0xf bank_mask:0xf
    v_add_f32_dpp v17, v17, v17 row_ror:8 row_mask:0xf bank_mask:0xf
    s_nop 0
    v_add_f32_dpp v16, v16, v16 row_ror:4 row_mask:0xf bank_mask:0xf
    v_add_f32_dpp v17, v17, v17 row_ror:4 row_mask:0xf bank_mask:0xf
    s_nop 0
    v_add_f32_dpp v16, v16, v16 row_ror:2 row_mask:0xf bank_mask:0xf
    v_add_f32_dpp v17, v17, v17 row_ror:2 row_mask:0xf bank_mask:0xf
    s_nop 0
    v_add_f32_dpp v16, v16, v16 row_ror:1 row_mask:0xf bank_mask:0xf
    v_add_f32_dpp v17, v17, v17 row_ror:1 row_mask:0xf bank_mask:0xf
    v_mov_b32 v18, v16
    v_mov_b32 v19, v17
    s_nop 0
    v_permlane16_swap_b32 v16, v18
    v_permlane16_swap_b32 v17, v19
    v_add_f32 v16, v16, v18
    v_add_f32 v17, v17, v19
    v_mov_b32 v18, v16
    v_mov_b32 v19, v17
    s_nop 0
    v_permlane32_swap_b32 v16, v18
    v_permlane32_swap_b32 v17, v19
    v_add_f32 v16, v16, v18
    v_add_f32 v17, v17, v19
    v_mov_b32 v18, v17
    v_mov_b32 v17, v16
    v_mov_b32 v16, s64
    v_mov_b32 v19, 0
    s_mov_b64 exec, 1
    ds_write_b128 v10, v[16:19] offset:640
    s_mov_b64 exec, -1
    s_waitcnt lgkmcnt(0)
    s_barrier
    s_waitcnt vmcnt(0)
    ds_read_b128 v[116:119], v11 offset:640
    ds_read_b128 v[120:123], v11 offset:656
    ds_read_b128 v[124:127], v11 offset:672
    ds_read_b128 v[128:131], v11 offset:688
    s_waitcnt lgkmcnt(0)
    v_add_f32 v16, v116, v120
    v_add_f32 v17, v124, v128
    v_add_f32 v18, v117, v121
    v_add_f32 v19, v125, v129
    v_add_f32 v16, v16, v17
    v_add_f32 v18, v18, v19
    v_mul_f32 v16, 0x43100000, v16
    v_add_f32 v16, v16, v18
    v_mul_f32 v16, 0x3ae38e39, v16
    v_sub_f32 v116, v116, v16
    v_sub_f32 v120, v120, v16
    v_sub_f32 v124, v124, v16
    v_sub_f32 v128, v128, v16
    v_add_f32 v117, v117, v117
    v_add_f32 v121, v121, v121
    v_add_f32 v125, v125, v125
    v_add_f32 v129, v129, v129
    v_fmac_f32 v117, 0x43100000, v116
    v_fmac_f32 v121, 0x43100000, v120
    v_fmac_f32 v125, 0x43100000, v124
    v_fmac_f32 v129, 0x43100000, v128
    v_fmac_f32 v118, v116, v117
    v_fmac_f32 v122, v120, v121
    v_fmac_f32 v126, v124, v125
    v_fmac_f32 v130, v128, v129
    v_add_f32 v17, v118, v122
    v_add_f32 v18, v126, v130
    v_add_f32 v17, v17, v18
    v_mul_f32 v17, 0x3ae38e39, v17
    v_cvt_pk_bf16_f32 v18, v16, v17
    v_lshlrev_b32 v16, 16, v18
    v_and_b32 v17, 0xffff0000, v18
    v_add_f32 v17, 0x3727c5ac, v17
    v_cvt_pk_bf16_f32 v18, v17, v17
    v_lshlrev_b32 v17, 16, v18
    v_sqrt_f32 v17, v17
    s_nop 0
    v_cvt_pk_bf16_f32 v18, v17, v17
    v_lshlrev_b32 v17, 16, v18
    v_rcp_f32 v17, v17
    v_sub_f32 v20, v20, v16
    v_sub_f32 v21, v21, v16
    v_sub_f32 v22, v22, v16
    v_sub_f32 v23, v23, v16
    v_cvt_pk_bf16_f32 v12, v20, v21
    v_cvt_pk_bf16_f32 v13, v22, v23
    v_lshlrev_b32 v20, 16, v12
    v_and_b32 v21, 0xffff0000, v12
    v_lshlrev_b32 v22, 16, v13
    v_and_b32 v23, 0xffff0000, v13
    v_mul_f32 v20, v20, v17
    v_mul_f32 v21, v21, v17
    v_mul_f32 v22, v22, v17
    v_mul_f32 v23, v23, v17
    v_cvt_pk_bf16_f32 v12, v20, v21
    v_cvt_pk_bf16_f32 v13, v22, v23
    v_lshlrev_b32 v20, 16, v12
    v_and_b32 v21, 0xffff0000, v12
    v_lshlrev_b32 v22, 16, v13
    v_and_b32 v23, 0xffff0000, v13
    v_mul_f32 v20, v20, v32
    v_mul_f32 v21, v21, v33
    v_mul_f32 v22, v22, v34
    v_mul_f32 v23, v23, v35
    v_cvt_pk_bf16_f32 v12, v20, v21
    v_cvt_pk_bf16_f32 v13, v22, v23
    v_lshlrev_b32 v20, 16, v12
    v_and_b32 v21, 0xffff0000, v12
    v_lshlrev_b32 v22, 16, v13
    v_and_b32 v23, 0xffff0000, v13
    v_add_f32 v20, v20, v28
    v_add_f32 v21, v21, v29
    v_add_f32 v22, v22, v30
    v_add_f32 v23, v23, v31
    v_cvt_pk_bf16_f32 v20, v20, v20
    v_cvt_pk_bf16_f32 v21, v21, v21
    v_cvt_pk_bf16_f32 v22, v22, v22
    v_cvt_pk_bf16_f32 v23, v23, v23
    s_mov_b32 exec_lo, 0xffffffff
    s_mov_b32 exec_hi, 0xf
    ds_write_b128 v8, v[20:23] offset:768
    s_mov_b64 exec, -1
    s_waitcnt lgkmcnt(0)
    s_barrier
    s_endpgm
L_qk:
    ds_read_b128 v[8:11], v0 offset:0
    s_waitcnt lgkmcnt(0)
    v_cndmask_b32 v12, 0, v8, s[66:67]
    v_cndmask_b32 v13, 0, v9, s[66:67]
    v_cndmask_b32 v14, 0, v10, s[66:67]
    v_cndmask_b32 v15, 0, v11, s[66:67]
    v_cndmask_b32 v8, v8, 0, s[66:67]
    v_cndmask_b32 v9, v9, 0, s[66:67]
    v_cndmask_b32 v10, v10, 0, s[66:67]
    v_cndmask_b32 v11, v11, 0, s[66:67]
    s_nop 1
    v_mfma_f32_16x16x32_bf16 v[16:19], v[40:43], v[8:11], 0
    v_mfma_f32_16x16x32_bf16 v[16:19], v[44:47], v[12:15], v[16:19]
    v_mfma_f32_16x16x32_bf16 v[40:43], v[48:51], v[8:11], 0
    v_mfma_f32_16x16x32_bf16 v[40:43], v[52:55], v[12:15], v[40:43]
    v_mfma_f32_16x16x32_bf16 v[48:51], v[56:59], v[8:11], 0
    v_mfma_f32_16x16x32_bf16 v[48:51], v[60:63], v[12:15], v[48:51]
    v_mfma_f32_16x16x32_bf16 v[56:59], v[64:67], v[8:11], 0
    v_mfma_f32_16x16x32_bf16 v[56:59], v[68:71], v[12:15], v[56:59]
    v_mfma_f32_16x16x32_bf16 v[64:67], v[72:75], v[8:11], 0
    v_mfma_f32_16x16x32_bf16 v[64:67], v[76:79], v[12:15], v[64:67]
    v_mfma_f32_16x16x32_bf16 v[72:75], v[80:83], v[8:11], 0
    v_mfma_f32_16x16x32_bf16 v[72:75], v[84:87], v[12:15], v[72:75]
    v_mfma_f32_16x16x32_bf16 v[80:83], v[88:91], v[8:11], 0
    v_mfma_f32_16x16x32_bf16 v[80:83], v[92:95], v[12:15], v[80:83]
    v_mfma_f32_16x16x32_bf16 v[88:91], v[96:99], v[8:11], 0
    v_mfma_f32_16x16x32_bf16 v[88:91], v[100:103], v[12:15], v[88:91]
    v_mov_b32_dpp v20, v16 quad_perm:[0,0,0,0] row_mask:0xf bank_mask:0xf
    v_mov_b32_dpp v21, v40 quad_perm:[0,0,0,0] row_mask:0xf bank_mask:0xf
    v_mov_b32_dpp v22, v48 quad_perm:[0,0,0,0] row_mask:0xf bank_mask:0xf
    v_mov_b32_dpp v23, v56 quad_perm:[0,0,0,0] row_mask:0xf bank_mask:0xf
    v_add_f32_dpp v20, v17, v20 quad_perm:[1,1,1,1] row_mask:0xf bank_mask:0xf
    v_add_f32_dpp v21, v41, v21 quad_perm:[1,1,1,1] row_mask:0xf bank_mask:0xf
    v_add_f32_dpp v22, v49, v22 quad_perm:[1,1,1,1] row_mask:0xf bank_mask:0xf
    v_add_f32_dpp v23, v57, v23 quad_perm:[1,1,1,1] row_mask:0xf bank_mask:0xf
    v_add_f32_dpp v20, v18, v20 quad_perm:[2,2,2,2] row_mask:0xf bank_mask:0xf
    v_add_f32_dpp v21, v42, v21 quad_perm:[2,2,2,2] row_mask:0xf bank_mask:0xf
    v_add_f32_dpp v22, v50, v22 quad_perm:[2,2,2,2] row_mask:0xf bank_mask:0xf
    v_add_f32_dpp v23, v58, v23 quad_perm:[2,2,2,2] row_mask:0xf bank_mask:0xf
    v_add_f32_dpp v20, v19, v20 quad_perm:[3,3,3,3] row_mask:0xf bank_mask:0xf
    v_add_f32_dpp v21, v43, v21 quad_perm:[3,3,3,3] row_mask:0xf bank_mask:0xf
    v_add_f32_dpp v22, v51, v22 quad_perm:[3,3,3,3] row_mask:0xf bank_mask:0xf
    v_add_f32_dpp v23, v59, v23 quad_perm:[3,3,3,3] row_mask:0xf bank_mask:0xf
    v_mov_b32_dpp v24, v64 quad_perm:[0,0,0,0] row_mask:0xf bank_mask:0xf
    v_mov_b32_dpp v25, v72 quad_perm:[0,0,0,0] row_mask:0xf bank_mask:0xf
    v_mov_b32_dpp v26, v80 quad_perm:[0,0,0,0] row_mask:0xf bank_mask:0xf
    v_mov_b32_dpp v27, v88 quad_perm:[0,0,0,0] row_mask:0xf bank_mask:0xf
    v_add_f32_dpp v24, v65, v24 quad_perm:[1,1,1,1] row_mask:0xf bank_mask:0xf
    v_add_f32_dpp v25, v73, v25 quad_perm:[1,1,1,1] row_mask:0xf bank_mask:0xf
    v_add_f32_dpp v26, v81, v26 quad_perm:[1,1,1,1] row_mask:0xf bank_mask:0xf
    v_add_f32_dpp v27, v89, v27 quad_perm:[1,1,1,1] row_mask:0xf bank_mask:0xf
    v_add_f32_dpp v24, v66, v24 quad_perm:[2,2,2,2] row_mask:0xf bank_mask:0xf
    v_add_f32_dpp v25, v74, v25 quad_perm:[2,2,2,2] row_mask:0xf bank_mask:0xf
    v_add_f32_dpp v26, v82, v26 quad_perm:[2,2,2,2] row_mask:0xf bank_mask:0xf
    v_add_f32_dpp v27, v90, v27 quad_perm:[2,2,2,2] row_mask:0xf bank_mask:0xf
    v_add_f32_dpp v24, v67, v24 quad_perm:[3,3,3,3] row_mask:0xf bank_mask:0xf
    v_add_f32_dpp v25, v75, v25 quad_perm:[3,3,3,3] row_mask:0xf bank_mask:0xf
    v_add_f32_dpp v26, v83, v26 quad_perm:[3,3,3,3] row_mask:0xf bank_mask:0xf
    v_add_f32_dpp v27, v91, v27 quad_perm:[3,3,3,3] row_mask:0xf bank_mask:0xf
    v_cvt_pk_bf16_f32 v8, v20, v21
    v_cvt_pk_bf16_f32 v9, v22, v23
    v_cvt_pk_bf16_f32 v10, v24, v25
    v_cvt_pk_bf16_f32 v11, v26, v27
    v_lshlrev_b32 v20, 16, v8
    v_and_b32 v21, 0xffff0000, v8
    v_lshlrev_b32 v22, 16, v9
    v_and_b32 v23, 0xffff0000, v9
    v_lshlrev_b32 v24, 16, v10
    v_and_b32 v25, 0xffff0000, v10
    v_lshlrev_b32 v26, 16, v11
    v_and_b32 v27, 0xffff0000, v11
    v_mul_f32 v20, s56, v20
    v_mul_f32 v21, s56, v21
    v_mul_f32 v22, s56, v22
    v_mul_f32 v23, s56, v23
    v_mul_f32 v24, s56, v24
    v_mul_f32 v25, s56, v25
    v_mul_f32 v26, s56, v26
    v_mul_f32 v27, s56, v27
    v_cvt_pk_bf16_f32 v8, v20, v21
    v_cvt_pk_bf16_f32 v9, v22, v23
    v_cvt_pk_bf16_f32 v10, v24, v25
    v_cvt_pk_bf16_f32 v11, v26, v27
    v_lshlrev_b32 v20, 16, v8
    v_and_b32 v21, 0xffff0000, v8
    v_lshlrev_b32 v22, 16, v9
    v_and_b32 v23, 0xffff0000, v9
    v_lshlrev_b32 v24, 16, v10
    v_and_b32 v25, 0xffff0000, v10
    v_lshlrev_b32 v26, 16, v11
    v_and_b32 v27, 0xffff0000, v11
    v_max3_f32 v16, v20, v21, v22
    v_max3_f32 v17, v23, v24, v25
    v_max3_f32 v16, v16, v26, v27
    v_max_f32 v16, v16, v17
    s_nop 1
    v_max_f32_dpp v16, v16, v16 row_half_mirror row_mask:0xf bank_mask:0xf
    v_mov_b32 v17, v16
    s_nop 1
    v_permlane16_swap_b32 v16, v17
    v_max_f32 v16, v16, v17
    v_mov_b32 v17, v16
    s_nop 1
    v_permlane32_swap_b32 v16, v17
    v_max_f32 v16, v16, v17
    s_mov_b64 exec, 0x101
    ds_write_b32 v39, v16 offset:512
    s_mov_b64 exec, -1
    v_mul_f32 v9, s57, v16
    v_sub_f32 v9, 0, v9
    v_fma_f32 v20, v20, s57, v9
    v_fma_f32 v21, v21, s57, v9
    v_fma_f32 v22, v22, s57, v9
    v_fma_f32 v23, v23, s57, v9
    v_fma_f32 v24, v24, s57, v9
    v_fma_f32 v25, v25, s57, v9
    v_fma_f32 v26, v26, s57, v9
    v_fma_f32 v27, v27, s57, v9
    v_exp_f32 v20, v20
    v_exp_f32 v21, v21
    v_exp_f32 v22, v22
    v_exp_f32 v23, v23
    v_exp_f32 v24, v24
    v_exp_f32 v25, v25
    v_exp_f32 v26, v26
    v_exp_f32 v27, v27
    v_add_f32 v8, v20, v21
    v_add_f32 v9, v22, v23
    v_add_f32 v10, v24, v25
    v_add_f32 v11, v26, v27
    v_cvt_pk_bf16_f32 v20, v20, v20
    v_cvt_pk_bf16_f32 v21, v21, v21
    v_cvt_pk_bf16_f32 v22, v22, v22
    v_cvt_pk_bf16_f32 v23, v23, v23
    v_cvt_pk_bf16_f32 v24, v24, v24
    v_cvt_pk_bf16_f32 v25, v25, v25
    v_cvt_pk_bf16_f32 v26, v26, v26
    v_cvt_pk_bf16_f32 v27, v27, v27
    v_add_f32 v8, v8, v9
    v_add_f32 v10, v10, v11
    v_add_f32 v10, v10, v8
    v_mov_b32_dpp v28, v20 row_half_mirror row_mask:0xf bank_mask:0xf
    v_mov_b32_dpp v29, v21 row_half_mirror row_mask:0xf bank_mask:0xf
    v_mov_b32_dpp v30, v22 row_half_mirror row_mask:0xf bank_mask:0xf
    v_mov_b32_dpp v31, v23 row_half_mirror row_mask:0xf bank_mask:0xf
    v_mov_b32_dpp v32, v24 row_half_mirror row_mask:0xf bank_mask:0xf
    v_mov_b32_dpp v33, v25 row_half_mirror row_mask:0xf bank_mask:0xf
    v_mov_b32_dpp v34, v26 row_half_mirror row_mask:0xf bank_mask:0xf
    v_mov_b32_dpp v35, v27 row_half_mirror row_mask:0xf bank_mask:0xf
    v_add_f32_dpp v10, v10, v10 row_half_mirror row_mask:0xf bank_mask:0xf
    v_mov_b32 v17, v10
    s_nop 1
    v_permlane16_swap_b32 v10, v17
    v_add_f32 v10, v10, v17
    v_mov_b32 v17, v10
    s_nop 1
    v_permlane32_swap_b32 v10, v17
    v_add_f32 v10, v10, v17
    s_mov_b64 exec, 0x101
    ds_write_b32 v39, v10 offset:576
    v_mov_b32 v16, 732
    v_mov_b32 v17, 1
    s_mov_b64 exec, 1
    ds_add_u32 v16, v17
    s_mov_b64 exec, -1
    s_mov_b32 s71, 1
    s_setpc_b64 s[74:75]
L_chain:
    s_setprio 3
    s_load_dword s42, s[40:41], 0
    s_sub_u32 s3, s3, 8
    s_mov_b32 s60, 1
    s_mov_b32 s6, s2
    s_cmp_lt_u32 s2, 108
    s_cbranch_scc1 L_p1role
    s_mov_b32 s60, 2
    s_sub_u32 s6, s2, 108
    s_cmp_lt_u32 s2, 236
    s_cbranch_scc1 L_p1role
    s_mov_b32 s60, 0
L_p1role:
    s_lshr_b32 s61, s6, 1
    s_and_b32 s62, s6, 1
    s_cmp_eq_u32 s3, 3
    s_cbranch_scc1 L_c3
    s_cmp_eq_u32 s3, 1
    s_cbranch_scc1 L_c1
    s_cmp_eq_u32 s3, 2
    s_cbranch_scc1 L_c2
L_c0:
    s_cmp_eq_u32 s60, 0
    s_cbranch_scc1 L_c0_skip
    s_mov_b32 s63, 6912
    s_mov_b32 s64, s34
    s_mov_b32 s65, s35
    s_cmp_eq_u32 s60, 1
    s_cbranch_scc1 L_c0_sel
    s_mov_b32 s63, 8192
    s_mov_b32 s64, s22
    s_mov_b32 s65, s23
L_c0_sel:
    s_mul_i32 s6, s62, 288
    s_mul_i32 s6, s6, s63
    s_lshl_b32 s7, s61, 7
    s_add_u32 s6, s6, s7
    s_add_u32 s48, s64, s6
    s_addc_u32 s49, s65, 0
    s_mul_i32 s50, s63, 288
    s_mov_b32 s51, 0x20000
    v_lshrrev_b32 v8, 3, v1
    v_mul_lo_u32 v8, v8, s63
    v_and_b32 v9, 7, v1
    v_lshlrev_b32 v9, 4, v9
    v_add_u32 v8, v8, v9
    s_lshl_b32 s66, s63, 3
    s_mov_b32 s67, 0
    buffer_load_dwordx4 v[24:27], v8, s[48:51], s67 offen nt
    s_add_u32 s67, s67, s66
    buffer_load_dwordx4 v[28:31], v8, s[48:51], s67 offen nt
    s_add_u32 s67, s67, s66
    buffer_load_dwordx4 v[32:35], v8, s[48:51], s67 offen nt
    s_add_u32 s67, s67, s66
    buffer_load_dwordx4 v[36:39], v8, s[48:51], s67 offen nt
    s_add_u32 s67, s67, s66
    buffer_load_dwordx4 v[40:43], v8, s[48:51], s67 offen nt
    s_add_u32 s67, s67, s66
    buffer_load_dwordx4 v[44:47], v8, s[48:51], s67 offen nt
    s_add_u32 s67, s67, s66
    buffer_load_dwordx4 v[48:51], v8, s[48:51], s67 offen nt
    s_add_u32 s67, s67, s66
    buffer_load_dwordx4 v[52:55], v8, s[48:51], s67 offen nt
    s_add_u32 s67, s67, s66
    buffer_load_dwordx4 v[56:59], v8, s[48:51], s67 offen nt
    s_add_u32 s67, s67, s66
    buffer_load_dwordx4 v[60:63], v8, s[48:51], s67 offen nt
    s_add_u32 s67, s67, s66
    buffer_load_dwordx4 v[64:67], v8, s[48:51], s67 offen nt
    s_add_u32 s67, s67, s66
    buffer_load_dwordx4 v[68:71], v8, s[48:51], s67 offen nt
    s_add_u32 s67, s67, s66
    buffer_load_dwordx4 v[72:75], v8, s[48:51], s67 offen nt
    s_add_u32 s67, s67, s66
    buffer_load_dwordx4 v[76:79], v8, s[48:51], s67 offen nt
    s_add_u32 s67, s67, s66
    buffer_load_dwordx4 v[80:83], v8, s[48:51], s67 offen nt
    s_add_u32 s67, s67, s66
    buffer_load_dwordx4 v[84:87], v8, s[48:51], s67 offen nt
    s_add_u32 s67, s67, s66
    buffer_load_dwordx4 v[88:91], v8, s[48:51], s67 offen nt
    s_add_u32 s67, s67, s66
    buffer_load_dwordx4 v[92:95], v8, s[48:51], s67 offen nt
    s_add_u32 s67, s67, s66
    buffer_load_dwordx4 v[96:99], v8, s[48:51], s67 offen nt
    s_add_u32 s67, s67, s66
    buffer_load_dwordx4 v[100:103], v8, s[48:51], s67 offen nt
    s_add_u32 s67, s67, s66
    buffer_load_dwordx4 v[104:107], v8, s[48:51], s67 offen nt
    s_add_u32 s67, s67, s66
    buffer_load_dwordx4 v[108:111], v8, s[48:51], s67 offen nt
    s_add_u32 s67, s67, s66
    buffer_load_dwordx4 v[112:115], v8, s[48:51], s67 offen nt
    s_add_u32 s67, s67, s66
    buffer_load_dwordx4 v[116:119], v8, s[48:51], s67 offen nt
    s_add_u32 s67, s67, s66
    buffer_load_dwordx4 v[120:123], v8, s[48:51], s67 offen nt
    s_add_u32 s67, s67, s66
    buffer_load_dwordx4 v[124:127], v8, s[48:51], s67 offen nt
    s_add_u32 s67, s67, s66
    buffer_load_dwordx4 v[128:131], v8, s[48:51], s67 offen nt
    s_add_u32 s67, s67, s66
    buffer_load_dwordx4 v[132:135], v8, s[48:51], s67 offen nt
    s_add_u32 s67, s67, s66
    buffer_load_dwordx4 v[136:139], v8, s[48:51], s67 offen nt
    s_add_u32 s67, s67, s66
    buffer_load_dwordx4 v[140:143], v8, s[48:51], s67 offen nt
    s_add_u32 s67, s67, s66
    buffer_load_dwordx4 v[144:147], v8, s[48:51], s67 offen nt
    s_add_u32 s67, s67, s66
    buffer_load_dwordx4 v[148:151], v8, s[48:51], s67 offen nt
    s_add_u32 s67, s67, s66
    buffer_load_dwordx4 v[152:155], v8, s[48:51], s67 offen nt
    s_add_u32 s67, s67, s66
    buffer_load_dwordx4 v[156:159], v8, s[48:51], s67 offen nt
    s_add_u32 s67, s67, s66
    buffer_load_dwordx4 v[160:163], v8, s[48:51], s67 offen nt
    s_add_u32 s67, s67, s66
    buffer_load_dwordx4 v[164:167], v8, s[48:51], s67 offen nt
    s_barrier
    v_and_b32 v9, 1, v1
    v_lshlrev_b32 v9, 4, v9
    v_mov_b32 v4, 0xffff
    v_lshlrev_b32 v7, v9, v4
    v_bfe_u32 v9, v1, 1, 2
    v_cmp_eq_u32 vcc, 0, v9
    s_nop 1
    v_cndmask_b32 v4, 0, v7, vcc
    v_cmp_eq_u32 vcc, 1, v9
    s_nop 1
    v_cndmask_b32 v5, 0, v7, vcc
    v_cmp_eq_u32 vcc, 2, v9
    s_nop 1
    v_cndmask_b32 v6, 0, v7, vcc
    v_cmp_eq_u32 vcc, 3, v9
    s_nop 1
    v_cndmask_b32 v7, 0, v7, vcc
    v_lshrrev_b32 v2, 3, v1
    v_mul_u32_u24 v2, 144, v2
    s_lshl_b32 s6, s61, 9
    s_mul_i32 s7, s62, 27648
    s_add_u32 s7, s7, 8192
    s_cmp_eq_u32 s60, 1
    s_cbranch_scc1 L_c0_pub
    s_mul_i32 s7, s62, 32768
    s_add_u32 s7, s7, 65536
L_c0_pub:
    s_add_u32 s68, s6, s7
    s_waitcnt lgkmcnt(0)
    s_add_u32 s42, s42, 1
    s_mov_b32 s43, 0
    v_mov_b32 v8, 704
L_c0_wxx:
    ds_read_b32 v9, v8
    s_waitcnt lgkmcnt(0)
    v_cmp_ne_u32 vcc, 1, v9
    s_cbranch_vccz L_c0_wxx_done
    s_add_u32 s43, s43, 1
    s_cmp_lt_u32 s43, 1600000
    s_cbranch_scc0 L_c0_wxx_done
    s_sleep 1
    s_branch L_c0_wxx
L_c0_wxx_done:
    ds_read_b128 v[8:11], v2 offset:5888
    s_waitcnt lgkmcnt(0)
    v_and_b32 v16, v8, v4
    v_and_b32 v17, v8, v5
    v_and_b32 v18, v8, v6
    v_and_b32 v19, v8, v7
    s_waitcnt vmcnt(35)
    s_nop 0
    v_mfma_f32_16x16x32_bf16 v[12:15], v[16:19], v[24:27], 0
    ds_read_b128 v[24:27], v2 offset:5904
    v_and_b32 v20, v9, v4
    v_and_b32 v21, v9, v5
    v_and_b32 v22, v9, v6
    v_and_b32 v23, v9, v7
    s_waitcnt vmcnt(34)
    s_nop 0
    v_mfma_f32_16x16x32_bf16 v[12:15], v[20:23], v[28:31], v[12:15]
    v_and_b32 v16, v10, v4
    v_and_b32 v17, v10, v5
    v_and_b32 v18, v10, v6
    v_and_b32 v19, v10, v7
    s_waitcnt vmcnt(33)
    s_nop 0
    v_mfma_f32_16x16x32_bf16 v[12:15], v[16:19], v[32:35], v[12:15]
    v_and_b32 v20, v11, v4
    v_and_b32 v21, v11, v5
    v_and_b32 v22, v11, v6
    v_and_b32 v23, v11, v7
    s_waitcnt vmcnt(32)
    s_nop 0
    v_mfma_f32_16x16x32_bf16 v[12:15], v[20:23], v[36:39], v[12:15]
    s_waitcnt lgkmcnt(0)
    v_and_b32 v16, v24, v4
    v_and_b32 v17, v24, v5
    v_and_b32 v18, v24, v6
    v_and_b32 v19, v24, v7
    s_waitcnt vmcnt(31)
    s_nop 0
    v_mfma_f32_16x16x32_bf16 v[12:15], v[16:19], v[40:43], v[12:15]
    ds_read_b128 v[40:43], v2 offset:5920
    v_and_b32 v20, v25, v4
    v_and_b32 v21, v25, v5
    v_and_b32 v22, v25, v6
    v_and_b32 v23, v25, v7
    s_waitcnt vmcnt(30)
    s_nop 0
    v_mfma_f32_16x16x32_bf16 v[12:15], v[20:23], v[44:47], v[12:15]
    v_and_b32 v16, v26, v4
    v_and_b32 v17, v26, v5
    v_and_b32 v18, v26, v6
    v_and_b32 v19, v26, v7
    s_waitcnt vmcnt(29)
    s_nop 0
    v_mfma_f32_16x16x32_bf16 v[12:15], v[16:19], v[48:51], v[12:15]
    v_and_b32 v20, v27, v4
    v_and_b32 v21, v27, v5
    v_and_b32 v22, v27, v6
    v_and_b32 v23, v27, v7
    s_waitcnt vmcnt(28)
    s_nop 0
    v_mfma_f32_16x16x32_bf16 v[12:15], v[20:23], v[52:55], v[12:15]
    s_waitcnt lgkmcnt(0)
    v_and_b32 v16, v40, v4
    v_and_b32 v17, v40, v5
    v_and_b32 v18, v40, v6
    v_and_b32 v19, v40, v7
    s_waitcnt vmcnt(27)
    s_nop 0
    v_mfma_f32_16x16x32_bf16 v[12:15], v[16:19], v[56:59], v[12:15]
    ds_read_b128 v[56:59], v2 offset:5936
    v_and_b32 v20, v41, v4
    v_and_b32 v21, v41, v5
    v_and_b32 v22, v41, v6
    v_and_b32 v23, v41, v7
    s_waitcnt vmcnt(26)
    s_nop 0
    v_mfma_f32_16x16x32_bf16 v[12:15], v[20:23], v[60:63], v[12:15]
    v_and_b32 v16, v42, v4
    v_and_b32 v17, v42, v5
    v_and_b32 v18, v42, v6
    v_and_b32 v19, v42, v7
    s_waitcnt vmcnt(25)
    s_nop 0
    v_mfma_f32_16x16x32_bf16 v[12:15], v[16:19], v[64:67], v[12:15]
    v_and_b32 v20, v43, v4
    v_and_b32 v21, v43, v5
    v_and_b32 v22, v43, v6
    v_and_b32 v23, v43, v7
    s_waitcnt vmcnt(24)
    s_nop 0
    v_mfma_f32_16x16x32_bf16 v[12:15], v[20:23], v[68:71], v[12:15]
    s_waitcnt lgkmcnt(0)
    v_and_b32 v16, v56, v4
    v_and_b32 v17, v56, v5
    v_and_b32 v18, v56, v6
    v_and_b32 v19, v56, v7
    s_waitcnt vmcnt(23)
    s_nop 0
    v_mfma_f32_16x16x32_bf16 v[12:15], v[16:19], v[72:75], v[12:15]
    ds_read_b128 v[72:75], v2 offset:5952
    v_and_b32 v20, v57, v4
    v_and_b32 v21, v57, v5
    v_and_b32 v22, v57, v6
    v_and_b32 v23, v57, v7
    s_waitcnt vmcnt(22)
    s_nop 0
    v_mfma_f32_16x16x32_bf16 v[12:15], v[20:23], v[76:79], v[12:15]
    v_and_b32 v16, v58, v4
    v_and_b32 v17, v58, v5
    v_and_b32 v18, v58, v6
    v_and_b32 v19, v58, v7
    s_waitcnt vmcnt(21)
    s_nop 0
    v_mfma_f32_16x16x32_bf16 v[12:15], v[16:19], v[80:83], v[12:15]
    v_and_b32 v20, v59, v4
    v_and_b32 v21, v59, v5
    v_and_b32 v22, v59, v6
    v_and_b32 v23, v59, v7
    s_waitcnt vmcnt(20)
    s_nop 0
    v_mfma_f32_16x16x32_bf16 v[12:15], v[20:23], v[84:87], v[12:15]
    s_waitcnt lgkmcnt(0)
    v_and_b32 v16, v72, v4
    v_and_b32 v17, v72, v5
    v_and_b32 v18, v72, v6
    v_and_b32 v19, v72, v7
    s_waitcnt vmcnt(19)
    s_nop 0
    v_mfma_f32_16x16x32_bf16 v[12:15], v[16:19], v[88:91], v[12:15]
    ds_read_b128 v[88:91], v2 offset:5968
    v_and_b32 v20, v73, v4
    v_and_b32 v21, v73, v5
    v_and_b32 v22, v73, v6
    v_and_b32 v23, v73, v7
    s_waitcnt vmcnt(18)
    s_nop 0
    v_mfma_f32_16x16x32_bf16 v[12:15], v[20:23], v[92:95], v[12:15]
    v_and_b32 v16, v74, v4
    v_and_b32 v17, v74, v5
    v_and_b32 v18, v74, v6
    v_and_b32 v19, v74, v7
    s_waitcnt vmcnt(17)
    s_nop 0
    v_mfma_f32_16x16x32_bf16 v[12:15], v[16:19], v[96:99], v[12:15]
    v_and_b32 v20, v75, v4
    v_and_b32 v21, v75, v5
    v_and_b32 v22, v75, v6
    v_and_b32 v23, v75, v7
    s_waitcnt vmcnt(16)
    s_nop 0
    v_mfma_f32_16x16x32_bf16 v[12:15], v[20:23], v[100:103], v[12:15]
    s_waitcnt lgkmcnt(0)
    v_and_b32 v16, v88, v4
    v_and_b32 v17, v88, v5
    v_and_b32 v18, v88, v6
    v_and_b32 v19, v88, v7
    s_waitcnt vmcnt(15)
    s_nop 0
    v_mfma_f32_16x16x32_bf16 v[12:15], v[16:19], v[104:107], v[12:15]
    ds_read_b128 v[104:107], v2 offset:5984
    v_and_b32 v20, v89, v4
    v_and_b32 v21, v89, v5
    v_and_b32 v22, v89, v6
    v_and_b32 v23, v89, v7
    s_waitcnt vmcnt(14)
    s_nop 0
    v_mfma_f32_16x16x32_bf16 v[12:15], v[20:23], v[108:111], v[12:15]
    v_and_b32 v16, v90, v4
    v_and_b32 v17, v90, v5
    v_and_b32 v18, v90, v6
    v_and_b32 v19, v90, v7
    s_waitcnt vmcnt(13)
    s_nop 0
    v_mfma_f32_16x16x32_bf16 v[12:15], v[16:19], v[112:115], v[12:15]
    v_and_b32 v20, v91, v4
    v_and_b32 v21, v91, v5
    v_and_b32 v22, v91, v6
    v_and_b32 v23, v91, v7
    s_waitcnt vmcnt(12)
    s_nop 0
    v_mfma_f32_16x16x32_bf16 v[12:15], v[20:23], v[116:119], v[12:15]
    s_waitcnt lgkmcnt(0)
    v_and_b32 v16, v104, v4
    v_and_b32 v17, v104, v5
    v_and_b32 v18, v104, v6
    v_and_b32 v19, v104, v7
    s_waitcnt vmcnt(11)
    s_nop 0
    v_mfma_f32_16x16x32_bf16 v[12:15], v[16:19], v[120:123], v[12:15]
    ds_read_b128 v[120:123], v2 offset:6000
    v_and_b32 v20, v105, v4
    v_and_b32 v21, v105, v5
    v_and_b32 v22, v105, v6
    v_and_b32 v23, v105, v7
    s_waitcnt vmcnt(10)
    s_nop 0
    v_mfma_f32_16x16x32_bf16 v[12:15], v[20:23], v[124:127], v[12:15]
    v_and_b32 v16, v106, v4
    v_and_b32 v17, v106, v5
    v_and_b32 v18, v106, v6
    v_and_b32 v19, v106, v7
    s_waitcnt vmcnt(9)
    s_nop 0
    v_mfma_f32_16x16x32_bf16 v[12:15], v[16:19], v[128:131], v[12:15]
    v_and_b32 v20, v107, v4
    v_and_b32 v21, v107, v5
    v_and_b32 v22, v107, v6
    v_and_b32 v23, v107, v7
    s_waitcnt vmcnt(8)
    s_nop 0
    v_mfma_f32_16x16x32_bf16 v[12:15], v[20:23], v[132:135], v[12:15]
    s_waitcnt lgkmcnt(0)
    v_and_b32 v16, v120, v4
    v_and_b32 v17, v120, v5
    v_and_b32 v18, v120, v6
    v_and_b32 v19, v120, v7
    s_waitcnt vmcnt(7)
    s_nop 0
    v_mfma_f32_16x16x32_bf16 v[12:15], v[16:19], v[136:139], v[12:15]
    ds_read_b128 v[136:139], v2 offset:6016
    v_and_b32 v20, v121, v4
    v_and_b32 v21, v121, v5
    v_and_b32 v22, v121, v6
    v_and_b32 v23, v121, v7
    s_waitcnt vmcnt(6)
    s_nop 0
    v_mfma_f32_16x16x32_bf16 v[12:15], v[20:23], v[140:143], v[12:15]
    v_and_b32 v16, v122, v4
    v_and_b32 v17, v122, v5
    v_and_b32 v18, v122, v6
    v_and_b32 v19, v122, v7
    s_waitcnt vmcnt(5)
    s_nop 0
    v_mfma_f32_16x16x32_bf16 v[12:15], v[16:19], v[144:147], v[12:15]
    v_and_b32 v20, v123, v4
    v_and_b32 v21, v123, v5
    v_and_b32 v22, v123, v6
    v_and_b32 v23, v123, v7
    s_waitcnt vmcnt(4)
    s_nop 0
    v_mfma_f32_16x16x32_bf16 v[12:15], v[20:23], v[148:151], v[12:15]
    s_waitcnt lgkmcnt(0)
    v_and_b32 v16, v136, v4
    v_and_b32 v17, v136, v5
    v_and_b32 v18, v136, v6
    v_and_b32 v19, v136, v7
    s_waitcnt vmcnt(3)
    s_nop 0
    v_mfma_f32_16x16x32_bf16 v[12:15], v[16:19], v[152:155], v[12:15]
    v_and_b32 v20, v137, v4
    v_and_b32 v21, v137, v5
    v_and_b32 v22, v137, v6
    v_and_b32 v23, v137, v7
    s_waitcnt vmcnt(2)
    s_nop 0
    v_mfma_f32_16x16x32_bf16 v[12:15], v[20:23], v[156:159], v[12:15]
    v_and_b32 v16, v138, v4
    v_and_b32 v17, v138, v5
    v_and_b32 v18, v138, v6
    v_and_b32 v19, v138, v7
    s_waitcnt vmcnt(1)
    s_nop 0
    v_mfma_f32_16x16x32_bf16 v[12:15], v[16:19], v[160:163], v[12:15]
    v_and_b32 v20, v139, v4
    v_and_b32 v21, v139, v5
    v_and_b32 v22, v139, v6
    v_and_b32 v23, v139, v7
    s_waitcnt vmcnt(0)
    s_nop 0
    v_mfma_f32_16x16x32_bf16 v[12:15], v[20:23], v[164:167], v[12:15]
    v_and_b32 v9, 7, v1
    v_lshlrev_b32 v9, 5, v9
    v_bfe_u32 v10, v1, 4, 1
    v_lshl_add_u32 v9, v10, 4, v9
    v_lshrrev_b32 v10, 5, v1
    v_lshl_add_u32 v9, v10, 3, v9
    v_lshlrev_b32 v9, 1, v9
    s_nop 0
    v_permlane32_swap_b32 v12, v14
    v_permlane32_swap_b32 v13, v15
    s_nop 0
    v_add_f32_dpp v16, v14, v12 row_ror:8 row_mask:0xf bank_mask:0xf
    v_add_f32_dpp v17, v15, v13 row_ror:8 row_mask:0xf bank_mask:0xf
    v_mov_b32 v18, v17
    v_mov_b32 v17, s42
    v_mov_b32 v19, s42
    s_mov_b32 exec_lo, 0xff00ff
    s_mov_b32 exec_hi, 0xff00ff
    buffer_store_dwordx4 v[16:19], v9, s[44:47], s68 offen sc1
    s_mov_b64 exec, -1
    s_branch L_ctail
L_c0_skip:
    s_barrier
    s_waitcnt lgkmcnt(0)
    s_add_u32 s42, s42, 1
    s_branch L_ctail
L_c1:
    v_mov_b32 v8, -1
    v_mov_b32 v9, -1
    v_mov_b32 v10, -1
    v_mov_b32 v11, -1
    v_lshlrev_b32 v12, 4, v1
    s_lshl_b32 s6, s59, 10
    s_add_u32 s6, s6, 131072
    buffer_store_dwordx4 v[8:11], v12, s[44:47], s6 offen sc1
    s_cmp_lt_u32 s5, 7
    s_cbranch_scc1 L_c1_ap
    s_mul_i32 s6, s58, 2304
    s_add_u32 s6, s6, 524288
    buffer_store_dwordx4 v[8:11], v12, s[44:47], s6 offen sc1
    buffer_store_dwordx4 v[8:11], v12, s[44:47], s6 offen offset:1024 sc1
    s_mov_b64 exec, 0xffff
    buffer_store_dwordx4 v[8:11], v12, s[44:47], s6 offen offset:2048 sc1
    s_mov_b64 exec, 0xff
    s_lshl_b32 s6, s58, 7
    s_add_u32 s6, s6, 499712
    buffer_store_dwordx4 v[8:11], v12, s[44:47], s6 offen sc1
    s_branch L_c1_st
L_c1_ap:
L_c1_apdummy:
L_c1_st:
    s_bitcmp1_b32 s4, 0
    s_cbranch_scc1 L_c1_norc
    s_cmp_ge_u32 s5, 9
    s_cbranch_scc1 L_c1_norc
    s_mov_b64 exec, 0xffff
    s_lshr_b32 s6, s4, 1
    s_mul_i32 s6, s6, 2304
    s_lshl_b32 s7, s5, 8
    s_add_u32 s6, s6, s7
    s_add_u32 s6, s6, 458752
    buffer_store_dwordx4 v[8:11], v12, s[44:47], s6 offen sc1
    s_cmp_lg_u32 s5, 0
    s_cbranch_scc1 L_c1_norc
    s_mov_b64 exec, 1
    v_mov_b32 v13, 0
    s_lshr_b32 s6, s4, 1
    s_lshl_b32 s6, s6, 7
    s_add_u32 s6, s6, 520192
    buffer_store_dword v13, v12, s[44:47], s6 offen sc1
L_c1_norc:
    s_mov_b64 exec, 1
    s_lshl_b32 s6, s59, 7
    s_add_u32 s6, s6, 393216
    buffer_store_dwordx4 v[8:11], v12, s[44:47], s6 offen sc1
    s_mov_b64 exec, -1
    s_barrier
    s_waitcnt vmcnt(0) lgkmcnt(0)
    s_add_u32 s42, s42, 1
    v_mov_b32 v13, s42
    s_lshl_b32 s6, s2, 2
    s_add_u32 s6, s6, 4096
    v_mov_b32 v15, 0
    s_mov_b64 exec, 1
    buffer_store_dword v13, v15, s[44:47], s6 offen sc1
    s_mov_b64 exec, -1
    v_lshlrev_b32 v8, 4, v1
    s_lshl_b32 s6, s4, 11
    s_add_u32 s6, s6, 65536
    s_add_u32 s7, s6, 32768
    s_add_u32 s64, s40, s6
    s_addc_u32 s65, s41, 0
    s_sleep 100
    s_sleep 70
    s_mov_b32 s43, 0
L_c1_q:
    buffer_load_dwordx4 v[112:115], v8, s[44:47], s6 offen sc1
    buffer_load_dwordx4 v[116:119], v8, s[44:47], s6 offen offset:1024 sc1
    buffer_load_dwordx4 v[120:123], v8, s[44:47], s7 offen sc1
    buffer_load_dwordx4 v[124:127], v8, s[44:47], s7 offen offset:1024 sc1
    s_waitcnt vmcnt(0)
    v_min_u32 v128, v113, v115
    v_max_u32 v129, v113, v115
    v_min3_u32 v128, v128, v117, v119
    v_max3_u32 v129, v129, v117, v119
    v_min3_u32 v128, v128, v121, v123
    v_max3_u32 v129, v129, v121, v123
    v_min3_u32 v128, v128, v125, v127
    v_max3_u32 v129, v129, v125, v127
    v_xor_b32 v128, s42, v128
    v_xor_b32 v129, s42, v129
    v_or_b32 v128, v128, v129
    v_cmp_ne_u32 vcc, 0, v128
    s_cbranch_vccz L_c1_q_done
    s_add_u32 s43, s43, 1
    s_cmp_lt_u32 s43, 200000
    s_cbranch_scc0 L_c1_q_done
    s_sleep 4
    s_branch L_c1_q
L_c1_q_done:
    v_add_f32 v112, v112, v120
    v_add_f32 v114, v114, v122
    v_add_f32 v116, v116, v124
    v_add_f32 v118, v118, v126
    v_cvt_pk_bf16_f32 v112, v112, v114
    v_cvt_pk_bf16_f32 v113, v116, v118
    v_lshlrev_b32 v8, 2, v1
    ds_write_b32 v8, v112 offset:0
    ds_write_b32 v8, v113 offset:256
    v_mov_b32 v8, 708
    v_mov_b32 v9, 1
    s_waitcnt lgkmcnt(0)
    s_mov_b64 exec, 1
    ds_write_b32 v8, v9
    s_mov_b64 exec, -1
    s_mov_b32 s43, 0
    v_mov_b32 v46, 732
L_c1_wq:
    ds_read_b32 v47, v46
    s_add_u32 s43, s43, 1
    s_cmp_lt_u32 s43, 1600000
    s_cbranch_scc0 L_c1_wq_done
    s_waitcnt lgkmcnt(0)
    v_cmp_ne_u32 vcc, 8, v47
    s_cbranch_vccz L_c1_wq_done
    s_sleep 1
    s_branch L_c1_wq
L_c1_wq_done:
    s_waitcnt lgkmcnt(0)
    s_cmp_lg_u32 s3, 1
    s_cbranch_scc1 L_nostatc
    v_bfe_u32 v12, v1, 3, 1
    v_lshlrev_b32 v12, 5, v12
    ds_read_b128 v[16:19], v12 offset:512
    ds_read_b128 v[20:23], v12 offset:528
    ds_read_b128 v[152:155], v12 offset:576
    ds_read_b128 v[156:159], v12 offset:592
    s_lshl_b32 s12, s59, 7
    s_add_u32 s12, s12, 393216
    v_lshrrev_b32 v12, 2, v12
    s_waitcnt lgkmcnt(0)
    v_max3_f32 v160, v16, v17, v18
    v_max3_f32 v161, v20, v21, v22
    v_max3_f32 v160, v160, v19, v23
    v_max_f32 v160, v160, v161
    v_sub_f32 v16, v16, v160
    v_sub_f32 v17, v17, v160
    v_sub_f32 v18, v18, v160
    v_sub_f32 v19, v19, v160
    v_sub_f32 v20, v20, v160
    v_sub_f32 v21, v21, v160
    v_sub_f32 v22, v22, v160
    v_sub_f32 v23, v23, v160
    v_mul_f32 v16, s57, v16
    v_mul_f32 v17, s57, v17
    v_mul_f32 v18, s57, v18
    v_mul_f32 v19, s57, v19
    v_mul_f32 v20, s57, v20
    v_mul_f32 v21, s57, v21
    v_mul_f32 v22, s57, v22
    v_mul_f32 v23, s57, v23
    v_exp_f32 v16, v16
    v_exp_f32 v17, v17
    v_exp_f32 v18, v18
    v_exp_f32 v19, v19
    v_exp_f32 v20, v20
    v_exp_f32 v21, v21
    v_exp_f32 v22, v22
    v_exp_f32 v23, v23
    v_mul_f32 v161, v16, v152
    v_fmac_f32 v161, v17, v153
    v_fmac_f32 v161, v18, v154
    v_fmac_f32 v161, v19, v155
    v_fmac_f32 v161, v20, v156
    v_fmac_f32 v161, v21, v157
    v_fmac_f32 v161, v22, v158
    v_fmac_f32 v161, v23, v159
    s_mov_b64 exec, 0x101
    buffer_store_dwordx2 v[160:161], v12, s[44:47], s12 offen sc1
    s_mov_b64 exec, -1
L_nostatc:
    s_branch L_ctail
L_c3:
    s_barrier
    s_waitcnt lgkmcnt(0)
    s_add_u32 s42, s42, 1
    s_sleep 127
    v_lshlrev_b32 v8, 4, v1
    s_mov_b32 s43, 0
    s_mov_b32 s6, 4096
L_c3_flags:
    buffer_load_dwordx4 v[12:15], v8, s[44:47], s6 offen sc1
    s_waitcnt vmcnt(0)
    v_min_u32 v9, v12, v13
    v_max_u32 v10, v12, v13
    v_min3_u32 v9, v9, v14, v15
    v_max3_u32 v10, v10, v14, v15
    v_xor_b32 v9, s42, v9
    v_xor_b32 v10, s42, v10
    v_or_b32 v9, v9, v10
    v_cmp_ne_u32 vcc, 0, v9
    s_cbranch_vccz L_c3_flags_done
    s_add_u32 s43, s43, 1
    s_cmp_lt_u32 s43, 200000
    s_cbranch_scc0 L_c3_flags_done
    s_sleep 32
    s_branch L_c3_flags
L_c3_flags_done:
    s_branch L_ctail
L_c2:
    v_mov_b32 v13, 0
    v_lshlrev_b32 v14, 2, v1
    s_mov_b64 exec, 0xffff
    ds_write_b32 v14, v13 offset:704
    s_mov_b64 exec, -1
    s_cmp_eq_u32 s60, 0
    s_cbranch_scc1 L_c2_skip
    s_cmp_eq_u32 s60, 2
    s_cbranch_scc1 L_c2_h
    s_mul_i32 s6, s62, 576
    s_add_u32 s48, s32, s6
    s_addc_u32 s49, s33, 0
    s_mov_b32 s50, 576
    s_mov_b32 s51, 0x20000
    v_lshlrev_b32 v8, 4, v1
    buffer_load_dwordx4 v[12:15], v8, s[48:51], 0 offen
    s_waitcnt lgkmcnt(0)
    s_barrier
    s_waitcnt vmcnt(0)
    s_add_u32 s42, s42, 1
    v_lshlrev_b32 v16, 16, v12
    v_and_b32 v17, 0xffff0000, v12
    v_lshlrev_b32 v18, 16, v13
    v_and_b32 v19, 0xffff0000, v13
    v_lshlrev_b32 v20, 16, v14
    v_and_b32 v21, 0xffff0000, v14
    v_lshlrev_b32 v22, 16, v15
    v_and_b32 v23, 0xffff0000, v15
    v_mul_f32 v24, 0xbfb8aa3b, v16
    v_mul_f32 v25, 0xbfb8aa3b, v17
    v_mul_f32 v26, 0xbfb8aa3b, v18
    v_mul_f32 v27, 0xbfb8aa3b, v19
    v_mul_f32 v28, 0xbfb8aa3b, v20
    v_mul_f32 v29, 0xbfb8aa3b, v21
    v_mul_f32 v30, 0xbfb8aa3b, v22
    v_mul_f32 v31, 0xbfb8aa3b, v23
    v_exp_f32 v24, v24
    v_exp_f32 v25, v25
    v_exp_f32 v26, v26
    v_exp_f32 v27, v27
    v_exp_f32 v28, v28
    v_exp_f32 v29, v29
    v_exp_f32 v30, v30
    v_exp_f32 v31, v31
    v_add_f32 v24, 1.0, v24
    v_add_f32 v25, 1.0, v25
    v_add_f32 v26, 1.0, v26
    v_add_f32 v27, 1.0, v27
    v_add_f32 v28, 1.0, v28
    v_add_f32 v29, 1.0, v29
    v_add_f32 v30, 1.0, v30
    v_add_f32 v31, 1.0, v31
    v_rcp_f32 v24, v24
    v_rcp_f32 v25, v25
    v_rcp_f32 v26, v26
    v_rcp_f32 v27, v27
    v_rcp_f32 v28, v28
    v_rcp_f32 v29, v29
    v_rcp_f32 v30, v30
    v_rcp_f32 v31, v31
    v_mul_f32 v16, v16, v24
    v_mul_f32 v17, v17, v25
    v_mul_f32 v18, v18, v26
    v_mul_f32 v19, v19, v27
    v_mul_f32 v20, v20, v28
    v_mul_f32 v21, v21, v29
    v_mul_f32 v22, v22, v30
    v_mul_f32 v23, v23, v31
    v_cvt_pk_bf16_f32 v16, v16, v16
    v_cvt_pk_bf16_f32 v17, v17, v17
    v_cvt_pk_bf16_f32 v18, v18, v18
    v_cvt_pk_bf16_f32 v19, v19, v19
    v_cvt_pk_bf16_f32 v20, v20, v20
    v_cvt_pk_bf16_f32 v21, v21, v21
    v_cvt_pk_bf16_f32 v22, v22, v22
    v_cvt_pk_bf16_f32 v23, v23, v23
    v_lshlrev_b32 v8, 2, v1
    s_mov_b32 exec_lo, 0xffffffff
    s_mov_b32 exec_hi, 0xf
    ds_write_b32 v8, v16 offset:5888
    ds_write_b32 v8, v17 offset:6032
    ds_write_b32 v8, v18 offset:6176
    ds_write_b32 v8, v19 offset:6320
    ds_write_b32 v8, v20 offset:6464
    ds_write_b32 v8, v21 offset:6608
    ds_write_b32 v8, v22 offset:6752
    ds_write_b32 v8, v23 offset:6896
    s_mov_b64 exec, -1
    s_branch L_c2_flag
L_c2_h:
    s_mov_b32 s48, s16
    s_mov_b32 s49, s17
    s_mov_b32 s50, 1152
    s_mov_b32 s51, 0x20000
    v_lshlrev_b32 v8, 5, v1
    buffer_load_dwordx4 v[12:15], v8, s[48:51], 0 offen
    buffer_load_dwordx4 v[16:19], v8, s[48:51], 0 offen offset:16
    s_mul_i32 s6, s62, 576
    v_lshlrev_b32 v9, 2, v1
    buffer_load_dword v20, v9, s[48:51], s6 offen
    buffer_load_dword v21, v9, s[48:51], s6 offen offset:256
    buffer_load_dword v22, v9, s[48:51], s6 offen offset:512
    s_waitcnt lgkmcnt(0)
    s_barrier
    s_waitcnt vmcnt(0)
    s_add_u32 s42, s42, 1
    v_lshlrev_b32 v32, 16, v12
    v_and_b32 v33, 0xffff0000, v12
    v_lshlrev_b32 v34, 16, v13
    v_and_b32 v35, 0xffff0000, v13
    v_lshlrev_b32 v36, 16, v14
    v_and_b32 v37, 0xffff0000, v14
    v_lshlrev_b32 v38, 16, v15
    v_and_b32 v39, 0xffff0000, v15
    v_lshlrev_b32 v40, 16, v16
    v_and_b32 v41, 0xffff0000, v16
    v_lshlrev_b32 v42, 16, v17
    v_and_b32 v43, 0xffff0000, v17
    v_lshlrev_b32 v44, 16, v18
    v_and_b32 v45, 0xffff0000, v18
    v_lshlrev_b32 v46, 16, v19
    v_and_b32 v47, 0xffff0000, v19
    v_add_f32 v26, v32, v33
    v_add_f32 v26, v26, v34
    v_add_f32 v26, v26, v35
    v_add_f32 v26, v26, v36
    v_add_f32 v26, v26, v37
    v_add_f32 v26, v26, v38
    v_add_f32 v26, v26, v39
    v_add_f32 v26, v26, v40
    v_add_f32 v26, v26, v41
    v_add_f32 v26, v26, v42
    v_add_f32 v26, v26, v43
    v_add_f32 v26, v26, v44
    v_add_f32 v26, v26, v45
    v_add_f32 v26, v26, v46
    v_add_f32 v26, v26, v47
    s_nop 1
    v_add_f32_dpp v26, v26, v26 row_ror:8 row_mask:0xf bank_mask:0xf
    s_nop 1
    v_add_f32_dpp v26, v26, v26 row_ror:4 row_mask:0xf bank_mask:0xf
    s_nop 1
    v_add_f32_dpp v26, v26, v26 row_ror:2 row_mask:0xf bank_mask:0xf
    s_nop 1
    v_add_f32_dpp v26, v26, v26 row_ror:1 row_mask:0xf bank_mask:0xf
    v_mov_b32 v27, v26
    s_nop 1
    v_permlane16_swap_b32 v26, v27
    v_add_f32 v26, v26, v27
    v_mov_b32 v27, v26
    s_nop 1
    v_permlane32_swap_b32 v26, v27
    v_add_f32 v26, v26, v27
    v_mul_f32 v24, 0x3ae38e39, v26
    v_mov_b32 v26, 0
    s_mov_b32 exec_lo, 0xffffffff
    s_mov_b32 exec_hi, 0xf
    v_sub_f32 v29, v32, v24
    v_fmac_f32 v26, v29, v29
    v_sub_f32 v29, v33, v24
    v_fmac_f32 v26, v29, v29
    v_sub_f32 v29, v34, v24
    v_fmac_f32 v26, v29, v29
    v_sub_f32 v29, v35, v24
    v_fmac_f32 v26, v29, v29
    v_sub_f32 v29, v36, v24
    v_fmac_f32 v26, v29, v29
    v_sub_f32 v29, v37, v24
    v_fmac_f32 v26, v29, v29
    v_sub_f32 v29, v38, v24
    v_fmac_f32 v26, v29, v29
    v_sub_f32 v29, v39, v24
    v_fmac_f32 v26, v29, v29
    v_sub_f32 v29, v40, v24
    v_fmac_f32 v26, v29, v29
    v_sub_f32 v29, v41, v24
    v_fmac_f32 v26, v29, v29
    v_sub_f32 v29, v42, v24
    v_fmac_f32 v26, v29, v29
    v_sub_f32 v29, v43, v24
    v_fmac_f32 v26, v29, v29
    v_sub_f32 v29, v44, v24
    v_fmac_f32 v26, v29, v29
    v_sub_f32 v29, v45, v24
    v_fmac_f32 v26, v29, v29
    v_sub_f32 v29, v46, v24
    v_fmac_f32 v26, v29, v29
    v_sub_f32 v29, v47, v24
    v_fmac_f32 v26, v29, v29
    s_mov_b64 exec, -1
    s_nop 0
    v_add_f32_dpp v26, v26, v26 row_ror:8 row_mask:0xf bank_mask:0xf
    s_nop 1
    v_add_f32_dpp v26, v26, v26 row_ror:4 row_mask:0xf bank_mask:0xf
    s_nop 1
    v_add_f32_dpp v26, v26, v26 row_ror:2 row_mask:0xf bank_mask:0xf
    s_nop 1
    v_add_f32_dpp v26, v26, v26 row_ror:1 row_mask:0xf bank_mask:0xf
    v_mov_b32 v27, v26
    s_nop 1
    v_permlane16_swap_b32 v26, v27
    v_add_f32 v26, v26, v27
    v_mov_b32 v27, v26
    s_nop 1
    v_permlane32_swap_b32 v26, v27
    v_add_f32 v26, v26, v27
    v_mul_f32 v25, 0x3ae38e39, v26
    v_cvt_pk_bf16_f32 v27, v24, v25
    v_lshlrev_b32 v24, 16, v27
    v_and_b32 v25, 0xffff0000, v27
    v_add_f32 v25, 0x3727c5ac, v25
    v_cvt_pk_bf16_f32 v27, v25, v25
    v_lshlrev_b32 v25, 16, v27
    v_sqrt_f32 v25, v25
    s_nop 0
    v_cvt_pk_bf16_f32 v27, v25, v25
    v_lshlrev_b32 v25, 16, v27
    v_rcp_f32 v25, v25
    v_lshlrev_b32 v32, 16, v20
    v_and_b32 v33, 0xffff0000, v20
    v_lshlrev_b32 v34, 16, v21
    v_and_b32 v35, 0xffff0000, v21
    v_lshlrev_b32 v36, 16, v22
    v_and_b32 v37, 0xffff0000, v22
    v_sub_f32 v32, v32, v24
    v_sub_f32 v33, v33, v24
    v_sub_f32 v34, v34, v24
    v_sub_f32 v35, v35, v24
    v_sub_f32 v36, v36, v24
    v_sub_f32 v37, v37, v24
    v_cvt_pk_bf16_f32 v26, v32, v33
    v_cvt_pk_bf16_f32 v27, v34, v35
    v_cvt_pk_bf16_f32 v28, v36, v37
    v_lshlrev_b32 v32, 16, v26
    v_and_b32 v33, 0xffff0000, v26
    v_lshlrev_b32 v34, 16, v27
    v_and_b32 v35, 0xffff0000, v27
    v_lshlrev_b32 v36, 16, v28
    v_and_b32 v37, 0xffff0000, v28
    v_mul_f32 v32, v32, v25
    v_mul_f32 v33, v33, v25
    v_mul_f32 v34, v34, v25
    v_mul_f32 v35, v35, v25
    v_mul_f32 v36, v36, v25
    v_mul_f32 v37, v37, v25
    v_cvt_pk_bf16_f32 v26, v32, v33
    v_cvt_pk_bf16_f32 v27, v34, v35
    v_cvt_pk_bf16_f32 v28, v36, v37
    v_lshlrev_b32 v32, 16, v26
    v_and_b32 v33, 0xffff0000, v26
    v_lshlrev_b32 v34, 16, v27
    v_and_b32 v35, 0xffff0000, v27
    v_lshlrev_b32 v36, 16, v28
    v_and_b32 v37, 0xffff0000, v28
    s_mul_i32 s6, s62, 2304
    s_add_u32 s6, s6, 8192
    s_add_u32 s7, s6, 27648
    s_add_u32 s8, s6, 4608
    s_add_u32 s9, s7, 4608
    v_lshlrev_b32 v8, 4, v1
    s_sleep 40
    s_mov_b32 s43, 0
L_c2_mod:
    buffer_load_dwordx4 v[64:67], v8, s[44:47], s6 offen sc1
    buffer_load_dwordx4 v[68:71], v8, s[44:47], s6 offen offset:1024 sc1
    buffer_load_dwordx4 v[76:79], v8, s[44:47], s8 offen sc1
    buffer_load_dwordx4 v[80:83], v8, s[44:47], s8 offen offset:1024 sc1
    buffer_load_dwordx4 v[88:91], v8, s[44:47], s7 offen sc1
    buffer_load_dwordx4 v[92:95], v8, s[44:47], s7 offen offset:1024 sc1
    buffer_load_dwordx4 v[100:103], v8, s[44:47], s9 offen sc1
    buffer_load_dwordx4 v[104:107], v8, s[44:47], s9 offen offset:1024 sc1
    v_mov_b32 v73, s42
    v_mov_b32 v75, s42
    v_mov_b32 v72, 0
    v_mov_b32 v74, 0
    v_mov_b32 v85, s42
    v_mov_b32 v87, s42
    v_mov_b32 v84, 0
    v_mov_b32 v86, 0
    v_mov_b32 v97, s42
    v_mov_b32 v99, s42
    v_mov_b32 v96, 0
    v_mov_b32 v98, 0
    v_mov_b32 v109, s42
    v_mov_b32 v111, s42
    v_mov_b32 v108, 0
    v_mov_b32 v110, 0
    s_mov_b64 exec, 0xffff
    buffer_load_dwordx4 v[72:75], v8, s[44:47], s6 offen offset:2048 sc1
    buffer_load_dwordx4 v[84:87], v8, s[44:47], s8 offen offset:2048 sc1
    buffer_load_dwordx4 v[96:99], v8, s[44:47], s7 offen offset:2048 sc1
    buffer_load_dwordx4 v[108:111], v8, s[44:47], s9 offen offset:2048 sc1
    s_mov_b64 exec, -1
    s_waitcnt vmcnt(0)
    v_min_u32 v48, v65, v67
    v_max_u32 v49, v65, v67
    v_min3_u32 v48, v48, v69, v71
    v_max3_u32 v49, v49, v69, v71
    v_min3_u32 v48, v48, v73, v75
    v_max3_u32 v49, v49, v73, v75
    v_min3_u32 v48, v48, v77, v79
    v_max3_u32 v49, v49, v77, v79
    v_min3_u32 v48, v48, v81, v83
    v_max3_u32 v49, v49, v81, v83
    v_min3_u32 v48, v48, v85, v87
    v_max3_u32 v49, v49, v85, v87
    v_min3_u32 v48, v48, v89, v91
    v_max3_u32 v49, v49, v89, v91
    v_min3_u32 v48, v48, v93, v95
    v_max3_u32 v49, v49, v93, v95
    v_min3_u32 v48, v48, v97, v99
    v_max3_u32 v49, v49, v97, v99
    v_min3_u32 v48, v48, v101, v103
    v_max3_u32 v49, v49, v101, v103
    v_min3_u32 v48, v48, v105, v107
    v_max3_u32 v49, v49, v105, v107
    v_min3_u32 v48, v48, v109, v111
    v_max3_u32 v49, v49, v109, v111
    v_xor_b32 v48, s42, v48
    v_xor_b32 v49, s42, v49
    v_or_b32 v48, v48, v49
    v_cmp_ne_u32 vcc, 0, v48
    s_cbranch_vccz L_c2_mod_done
    s_add_u32 s43, s43, 1
    s_cmp_lt_u32 s43, 200000
    s_cbranch_scc0 L_c2_mod_done
    s_sleep 4
    s_branch L_c2_mod
L_c2_mod_done:
    v_add_f32 v48, v64, v88
    v_add_f32 v56, v76, v100
    v_add_f32 v49, v66, v90
    v_add_f32 v57, v78, v102
    v_add_f32 v50, v68, v92
    v_add_f32 v58, v80, v104
    v_add_f32 v51, v70, v94
    v_add_f32 v59, v82, v106
    v_add_f32 v52, v72, v96
    v_add_f32 v60, v84, v108
    v_add_f32 v53, v74, v98
    v_add_f32 v61, v86, v110
    v_cvt_pk_bf16_f32 v64, v48, v49
    v_cvt_pk_bf16_f32 v65, v50, v51
    v_cvt_pk_bf16_f32 v66, v52, v53
    v_cvt_pk_bf16_f32 v67, v56, v57
    v_cvt_pk_bf16_f32 v68, v58, v59
    v_cvt_pk_bf16_f32 v69, v60, v61
    v_lshlrev_b32 v48, 16, v64
    v_and_b32 v49, 0xffff0000, v64
    v_lshlrev_b32 v50, 16, v65
    v_and_b32 v51, 0xffff0000, v65
    v_lshlrev_b32 v52, 16, v66
    v_and_b32 v53, 0xffff0000, v66
    v_lshlrev_b32 v56, 16, v67
    v_and_b32 v57, 0xffff0000, v67
    v_lshlrev_b32 v58, 16, v68
    v_and_b32 v59, 0xffff0000, v68
    v_lshlrev_b32 v60, 16, v69
    v_and_b32 v61, 0xffff0000, v69
    v_add_f32 v56, 1.0, v56
    v_add_f32 v57, 1.0, v57
    v_add_f32 v58, 1.0, v58
    v_add_f32 v59, 1.0, v59
    v_add_f32 v60, 1.0, v60
    v_add_f32 v61, 1.0, v61
    v_cvt_pk_bf16_f32 v64, v56, v57
    v_cvt_pk_bf16_f32 v65, v58, v59
    v_cvt_pk_bf16_f32 v66, v60, v61
    v_lshlrev_b32 v56, 16, v64
    v_and_b32 v57, 0xffff0000, v64
    v_lshlrev_b32 v58, 16, v65
    v_and_b32 v59, 0xffff0000, v65
    v_lshlrev_b32 v60, 16, v66
    v_and_b32 v61, 0xffff0000, v66
    v_mul_f32 v32, v32, v56
    v_mul_f32 v33, v33, v57
    v_mul_f32 v34, v34, v58
    v_mul_f32 v35, v35, v59
    v_mul_f32 v36, v36, v60
    v_mul_f32 v37, v37, v61
    v_cvt_pk_bf16_f32 v64, v32, v33
    v_cvt_pk_bf16_f32 v65, v34, v35
    v_cvt_pk_bf16_f32 v66, v36, v37
    v_lshlrev_b32 v32, 16, v64
    v_and_b32 v33, 0xffff0000, v64
    v_lshlrev_b32 v34, 16, v65
    v_and_b32 v35, 0xffff0000, v65
    v_lshlrev_b32 v36, 16, v66
    v_and_b32 v37, 0xffff0000, v66
    v_add_f32 v16, v32, v48
    v_add_f32 v17, v33, v49
    v_add_f32 v18, v34, v50
    v_add_f32 v19, v35, v51
    v_add_f32 v20, v36, v52
    v_add_f32 v21, v37, v53
    v_cvt_pk_bf16_f32 v16, v16, v16
    v_cvt_pk_bf16_f32 v17, v17, v17
    v_cvt_pk_bf16_f32 v18, v18, v18
    v_cvt_pk_bf16_f32 v19, v19, v19
    v_cvt_pk_bf16_f32 v20, v20, v20
    v_cvt_pk_bf16_f32 v21, v21, v21
    v_and_b32 v8, 3, v1
    v_mul_u32_u24 v8, 288, v8
    v_lshrrev_b32 v9, 2, v1
    v_lshlrev_b32 v9, 2, v9
    v_add_u32 v8, v8, v9
    ds_write_b32 v8, v16 offset:5888
    ds_write_b32 v8, v17 offset:6032
    ds_write_b32 v8, v18 offset:5952
    ds_write_b32 v8, v19 offset:6096
    s_mov_b64 exec, 0xffff
    ds_write_b32 v8, v20 offset:6016
    ds_write_b32 v8, v21 offset:6160
    s_mov_b64 exec, -1
L_c2_flag:
    v_mov_b32 v13, 1
    v_mov_b32 v14, 704
    s_waitcnt lgkmcnt(0)
    s_mov_b64 exec, 1
    ds_write_b32 v14, v13
    s_mov_b64 exec, -1
    s_branch L_ctail
L_c2_skip:
    s_waitcnt lgkmcnt(0)
    s_barrier
    s_add_u32 s42, s42, 1
L_ctail:
    v_and_b32 v8, 1, v1
    v_lshlrev_b32 v8, 4, v8
    v_mov_b32 v4, 0xffff
    v_lshlrev_b32 v7, v8, v4
    v_bfe_u32 v8, v1, 1, 2
    v_cmp_eq_u32 vcc, 0, v8
    s_nop 1
    v_cndmask_b32 v4, 0, v7, vcc
    v_cmp_eq_u32 vcc, 1, v8
    s_nop 1
    v_cndmask_b32 v5, 0, v7, vcc
    v_cmp_eq_u32 vcc, 2, v8
    s_nop 1
    v_cndmask_b32 v6, 0, v7, vcc
    v_cmp_eq_u32 vcc, 3, v8
    s_nop 1
    v_cndmask_b32 v7, 0, v7, vcc
    s_cmp_lg_u32 s3, 3
    s_cbranch_scc1 L_ct_norole
    s_mov_b32 s43, 0
    v_mov_b32 v46, 728
L_ct_wv:
    ds_read_b32 v47, v46
    s_add_u32 s43, s43, 1
    s_cmp_lt_u32 s43, 1600000
    s_cbranch_scc0 L_ct_wv_done
    s_waitcnt lgkmcnt(0)
    v_cmp_ne_u32 vcc, 8, v47
    s_cbranch_vccz L_ct_wv_done
    s_sleep 1
    s_branch L_ct_wv
L_ct_wv_done:
    s_waitcnt lgkmcnt(0)
    v_mov_b32 v46, 1
    v_mov_b32 v47, 0
    s_lshr_b32 s6, s4, 1
    s_lshl_b32 s6, s6, 7
    s_add_u32 s6, s6, 520192
    s_mov_b64 exec, 1
    buffer_atomic_add v46, v47, s[44:47], s6 offen sc0 sc1
    s_waitcnt vmcnt(0)
    v_and_b32 v46, 31, v46
    v_add_u32 v46, 1, v46
    v_mov_b32 v47, 724
    ds_write_b32 v47, v46
    s_mov_b64 exec, -1
L_ct_norole:
    v_mov_b32 v46, 724
    s_mov_b32 s43, 0
L_ct_role:
    ds_read_b32 v47, v46
    s_add_u32 s43, s43, 1
    s_cmp_lt_u32 s43, 1600000
    s_cbranch_scc0 L_ct_role_done
    s_waitcnt lgkmcnt(0)
    v_readfirstlane_b32 s70, v47
    s_nop 0
    s_cmp_lg_u32 s70, 0
    s_cbranch_scc1 L_ct_role_done
    s_sleep 1
    s_branch L_ct_role
L_ct_role_done:
    s_waitcnt lgkmcnt(0)
    s_sub_u32 s70, s70, 1
    s_cmp_lt_u32 s70, 9
    s_cbranch_scc1 L_ct_wor
    s_cmp_lt_u32 s70, 27
    s_cbranch_scc1 L_ct_ffn2
    s_lshr_b32 s6, s4, 1
    s_mul_i32 s69, s6, 5
    s_add_u32 s69, s69, s70
    s_sub_u32 s69, s69, 27
    s_cmp_ge_u32 s69, 36
    s_cbranch_scc1 L_ct_end
    s_cmp_lg_u32 s3, 3
    s_cbranch_scc1 L_ct_end
    s_mov_b32 s52, s16
    s_mov_b32 s53, s17
    s_mov_b32 s54, 1152
    s_mov_b32 s55, 0x20000
    v_and_b32 v8, 3, v1
    v_lshlrev_b32 v9, 5, v8
    v_lshlrev_b32 v8, 3, v8
    s_lshl_b32 s6, s69, 5
    buffer_load_dwordx2 v[40:41], v8, s[52:55], s6 offen
    s_lshl_b32 s7, s69, 7
    s_add_u32 s8, s7, 17408
    s_add_u32 s9, s8, 27648
    s_add_u32 s10, s8, 13824
    s_add_u32 s11, s9, 13824
    s_mov_b32 s43, 0
L_ct_red:
    buffer_load_dwordx4 v[128:131], v9, s[44:47], s8 offen sc1
    buffer_load_dwordx4 v[132:135], v9, s[44:47], s8 offen offset:16 sc1
    buffer_load_dwordx4 v[136:139], v9, s[44:47], s10 offen sc1
    buffer_load_dwordx4 v[140:143], v9, s[44:47], s10 offen offset:16 sc1
    buffer_load_dwordx4 v[144:147], v9, s[44:47], s9 offen sc1
    buffer_load_dwordx4 v[148:151], v9, s[44:47], s9 offen offset:16 sc1
    buffer_load_dwordx4 v[152:155], v9, s[44:47], s11 offen sc1
    buffer_load_dwordx4 v[156:159], v9, s[44:47], s11 offen offset:16 sc1
    s_waitcnt vmcnt(0)
    v_min_u32 v44, v129, v131
    v_max_u32 v45, v129, v131
    v_min3_u32 v44, v44, v133, v135
    v_max3_u32 v45, v45, v133, v135
    v_min3_u32 v44, v44, v137, v139
    v_max3_u32 v45, v45, v137, v139
    v_min3_u32 v44, v44, v141, v143
    v_max3_u32 v45, v45, v141, v143
    v_min3_u32 v44, v44, v145, v147
    v_max3_u32 v45, v45, v145, v147
    v_min3_u32 v44, v44, v149, v151
    v_max3_u32 v45, v45, v149, v151
    v_min3_u32 v44, v44, v153, v155
    v_max3_u32 v45, v45, v153, v155
    v_min3_u32 v44, v44, v157, v159
    v_max3_u32 v45, v45, v157, v159
    v_xor_b32 v44, s42, v44
    v_xor_b32 v45, s42, v45
    v_or_b32 v44, v44, v45
    v_cmp_ne_u32 vcc, 0, v44
    s_cbranch_vccz L_ct_red_done
    s_add_u32 s43, s43, 1
    s_cmp_lt_u32 s43, 200000
    s_cbranch_scc0 L_ct_red_done
    s_sleep 4
    s_branch L_ct_red
L_ct_red_done:
    v_add_f32 v24, v128, v144
    v_add_f32 v25, v130, v146
    v_add_f32 v26, v132, v148
    v_add_f32 v27, v134, v150
    v_add_f32 v28, v136, v152
    v_add_f32 v29, v138, v154
    v_add_f32 v30, v140, v156
    v_add_f32 v31, v142, v158
    v_cvt_pk_bf16_f32 v44, v24, v25
    v_cvt_pk_bf16_f32 v45, v26, v27
    v_cvt_pk_bf16_f32 v46, v28, v29
    v_cvt_pk_bf16_f32 v47, v30, v31
    v_lshlrev_b32 v24, 16, v44
    v_and_b32 v25, 0xffff0000, v44
    v_lshlrev_b32 v26, 16, v45
    v_and_b32 v27, 0xffff0000, v45
    v_lshlrev_b32 v28, 16, v46
    v_and_b32 v29, 0xffff0000, v46
    v_lshlrev_b32 v30, 16, v47
    v_and_b32 v31, 0xffff0000, v47
    v_lshlrev_b32 v36, 16, v40
    v_and_b32 v37, 0xffff0000, v40
    v_lshlrev_b32 v38, 16, v41
    v_and_b32 v39, 0xffff0000, v41
    v_lshrrev_b32 v8, 2, v1
    v_mul_u32_u24 v8, 2304, v8
    v_and_b32 v9, 3, v1
    v_lshl_add_u32 v8, v9, 4, v8
    s_lshl_b32 s7, s69, 6
    s_add_u32 s6, s7, 458752
    s_mov_b32 s48, s36
    s_mov_b32 s49, s37
    s_mov_b32 s50, 1152
    s_mov_b32 s51, 0x20000
    s_mov_b32 s43, 0
L_r1:
    v_mov_b32 v12, 0
    v_mov_b32 v13, 0
    v_mov_b32 v14, 0
    v_mov_b32 v15, 0
    s_mov_b32 exec_hi, 0
    buffer_load_dwordx4 v[12:15], v8, s[44:47], s6 offen sc1
    s_mov_b64 exec, -1
    s_waitcnt vmcnt(0)
    v_add_f32_dpp v12, v12, v12 row_ror:8 row_mask:0xf bank_mask:0xf
    v_add_f32_dpp v13, v13, v13 row_ror:8 row_mask:0xf bank_mask:0xf
    v_add_f32_dpp v14, v14, v14 row_ror:8 row_mask:0xf bank_mask:0xf
    v_add_f32_dpp v15, v15, v15 row_ror:8 row_mask:0xf bank_mask:0xf
    v_add_f32_dpp v12, v12, v12 row_ror:4 row_mask:0xf bank_mask:0xf
    v_add_f32_dpp v13, v13, v13 row_ror:4 row_mask:0xf bank_mask:0xf
    v_add_f32_dpp v14, v14, v14 row_ror:4 row_mask:0xf bank_mask:0xf
    v_add_f32_dpp v15, v15, v15 row_ror:4 row_mask:0xf bank_mask:0xf
    v_mov_b32 v16, v12
    v_mov_b32 v17, v13
    v_mov_b32 v18, v14
    v_mov_b32 v19, v15
    v_permlane16_swap_b32 v12, v16
    v_permlane16_swap_b32 v13, v17
    v_permlane16_swap_b32 v14, v18
    v_permlane16_swap_b32 v15, v19
    v_add_f32 v12, v12, v16
    v_add_f32 v13, v13, v17
    v_add_f32 v14, v14, v18
    v_add_f32 v15, v15, v19
    v_mov_b32 v16, v12
    v_mov_b32 v17, v13
    v_mov_b32 v18, v14
    v_mov_b32 v19, v15
    v_permlane32_swap_b32 v12, v16
    v_permlane32_swap_b32 v13, v17
    v_permlane32_swap_b32 v14, v18
    v_permlane32_swap_b32 v15, v19
    v_add_f32 v12, v12, v16
    v_add_f32 v13, v13, v17
    v_add_f32 v14, v14, v18
    v_add_f32 v15, v15, v19
    v_add_f32 v16, v12, v13
    v_add_f32 v17, v14, v15
    v_add_f32 v16, v16, v17
    v_cmp_u_f32 vcc, v16, v16
    s_cbranch_vccz L_r1_done
    s_add_u32 s43, s43, 1
    s_cmp_lt_u32 s43, 200000
    s_cbranch_scc0 L_r1_done
    s_sleep 2
    s_branch L_r1
L_r1_done:
    v_cvt_pk_bf16_f32 v16, v12, v13
    v_cvt_pk_bf16_f32 v17, v14, v15
    v_lshlrev_b32 v12, 16, v16
    v_and_b32 v13, 0xffff0000, v16
    v_lshlrev_b32 v14, 16, v17
    v_and_b32 v15, 0xffff0000, v17
    v_mul_f32 v12, v12, v24
    v_mul_f32 v13, v13, v25
    v_mul_f32 v14, v14, v26
    v_mul_f32 v15, v15, v27
    v_cvt_pk_bf16_f32 v16, v12, v13
    v_cvt_pk_bf16_f32 v17, v14, v15
    v_lshlrev_b32 v12, 16, v16
    v_and_b32 v13, 0xffff0000, v16
    v_lshlrev_b32 v14, 16, v17
    v_and_b32 v15, 0xffff0000, v17
    v_add_f32 v32, v12, v36
    v_add_f32 v33, v13, v37
    v_add_f32 v34, v14, v38
    v_add_f32 v35, v15, v39
    v_cvt_pk_bf16_f32 v16, v32, v33
    v_cvt_pk_bf16_f32 v17, v34, v35
    v_lshlrev_b32 v32, 16, v16
    v_and_b32 v33, 0xffff0000, v16
    v_lshlrev_b32 v34, 16, v17
    v_and_b32 v35, 0xffff0000, v17
    v_lshlrev_b32 v10, 3, v1
    s_lshl_b32 s10, s69, 5
    v_mov_b32 v14, s42
    v_mov_b32 v15, 0
    s_add_u32 s7, s7, 524288
    s_mov_b32 s6, s7
    buffer_load_dwordx4 v[96:99], v8, s[44:47], s6 offen sc1
    s_add_u32 s6, s6, 36864
    buffer_load_dwordx4 v[100:103], v8, s[44:47], s6 offen sc1
    s_add_u32 s6, s6, 36864
    buffer_load_dwordx4 v[104:107], v8, s[44:47], s6 offen sc1
    s_add_u32 s6, s6, 36864
    buffer_load_dwordx4 v[108:111], v8, s[44:47], s6 offen sc1
    s_add_u32 s6, s6, 36864
    buffer_load_dwordx4 v[112:115], v8, s[44:47], s6 offen sc1
    s_add_u32 s6, s6, 36864
    buffer_load_dwordx4 v[116:119], v8, s[44:47], s6 offen sc1
    s_add_u32 s6, s6, 36864
    buffer_load_dwordx4 v[120:123], v8, s[44:47], s6 offen sc1
    s_add_u32 s6, s6, 36864
    buffer_load_dwordx4 v[124:127], v8, s[44:47], s6 offen sc1
    s_add_u32 s6, s6, 36864
    buffer_load_dwordx4 v[128:131], v8, s[44:47], s6 offen sc1
    s_sleep 8
    s_mov_b32 s43, 0
L_r2:
    s_mov_b32 s6, s7
    buffer_load_dwordx4 v[132:135], v8, s[44:47], s6 offen sc1
    s_add_u32 s6, s6, 36864
    buffer_load_dwordx4 v[136:139], v8, s[44:47], s6 offen sc1
    s_add_u32 s6, s6, 36864
    buffer_load_dwordx4 v[140:143], v8, s[44:47], s6 offen sc1
    s_add_u32 s6, s6, 36864
    buffer_load_dwordx4 v[144:147], v8, s[44:47], s6 offen sc1
    s_add_u32 s6, s6, 36864
    buffer_load_dwordx4 v[148:151], v8, s[44:47], s6 offen sc1
    s_add_u32 s6, s6, 36864
    buffer_load_dwordx4 v[152:155], v8, s[44:47], s6 offen sc1
    s_add_u32 s6, s6, 36864
    buffer_load_dwordx4 v[156:159], v8, s[44:47], s6 offen sc1
    s_add_u32 s6, s6, 36864
    buffer_load_dwordx4 v[160:163], v8, s[44:47], s6 offen sc1
    s_add_u32 s6, s6, 36864
    buffer_load_dwordx4 v[164:167], v8, s[44:47], s6 offen sc1
    s_waitcnt vmcnt(9)
    v_max3_u32 v16, v96, v97, v98
    v_max3_u32 v17, v99, v100, v101
    v_max3_u32 v16, v16, v102, v103
    v_max3_u32 v17, v17, v104, v105
    v_max3_u32 v16, v16, v106, v107
    v_max3_u32 v17, v17, v108, v109
    v_max3_u32 v16, v16, v110, v111
    v_max3_u32 v17, v17, v112, v113
    v_max3_u32 v16, v16, v114, v115
    v_max3_u32 v17, v17, v116, v117
    v_max3_u32 v16, v16, v118, v119
    v_max3_u32 v17, v17, v120, v121
    v_max3_u32 v16, v16, v122, v123
    v_max3_u32 v17, v17, v124, v125
    v_max3_u32 v16, v16, v126, v127
    v_max3_u32 v17, v17, v128, v129
    v_max3_u32 v16, v16, v130, v131
    v_max_u32 v16, v16, v17
    v_cmp_eq_u32 vcc, -1, v16
    s_cbranch_vccz L_r2_useA
    s_mov_b32 s6, s7
    buffer_load_dwordx4 v[96:99], v8, s[44:47], s6 offen sc1
    s_add_u32 s6, s6, 36864
    buffer_load_dwordx4 v[100:103], v8, s[44:47], s6 offen sc1
    s_add_u32 s6, s6, 36864
    buffer_load_dwordx4 v[104:107], v8, s[44:47], s6 offen sc1
    s_add_u32 s6, s6, 36864
    buffer_load_dwordx4 v[108:111], v8, s[44:47], s6 offen sc1
    s_add_u32 s6, s6, 36864
    buffer_load_dwordx4 v[112:115], v8, s[44:47], s6 offen sc1
    s_add_u32 s6, s6, 36864
    buffer_load_dwordx4 v[116:119], v8, s[44:47], s6 offen sc1
    s_add_u32 s6, s6, 36864
    buffer_load_dwordx4 v[120:123], v8, s[44:47], s6 offen sc1
    s_add_u32 s6, s6, 36864
    buffer_load_dwordx4 v[124:127], v8, s[44:47], s6 offen sc1
    s_add_u32 s6, s6, 36864
    buffer_load_dwordx4 v[128:131], v8, s[44:47], s6 offen sc1
    s_waitcnt vmcnt(9)
    v_max3_u32 v16, v132, v133, v134
    v_max3_u32 v17, v135, v136, v137
    v_max3_u32 v16, v16, v138, v139
    v_max3_u32 v17, v17, v140, v141
    v_max3_u32 v16, v16, v142, v143
    v_max3_u32 v17, v17, v144, v145
    v_max3_u32 v16, v16, v146, v147
    v_max3_u32 v17, v17, v148, v149
    v_max3_u32 v16, v16, v150, v151
    v_max3_u32 v17, v17, v152, v153
    v_max3_u32 v16, v16, v154, v155
    v_max3_u32 v17, v17, v156, v157
    v_max3_u32 v16, v16, v158, v159
    v_max3_u32 v17, v17, v160, v161
    v_max3_u32 v16, v16, v162, v163
    v_max3_u32 v17, v17, v164, v165
    v_max3_u32 v16, v16, v166, v167
    v_max_u32 v16, v16, v17
    v_cmp_eq_u32 vcc, -1, v16
    s_cbranch_vccz L_r2_useB
    s_add_u32 s43, s43, 1
    s_cmp_lt_u32 s43, 200000
    s_cbranch_scc1 L_r2
L_r2_useB:
    v_add_f32 v132, v132, v136
    v_add_f32 v133, v133, v137
    v_add_f32 v134, v134, v138
    v_add_f32 v135, v135, v139
    v_add_f32 v140, v140, v144
    v_add_f32 v141, v141, v145
    v_add_f32 v142, v142, v146
    v_add_f32 v143, v143, v147
    v_add_f32 v148, v148, v152
    v_add_f32 v149, v149, v153
    v_add_f32 v150, v150, v154
    v_add_f32 v151, v151, v155
    v_add_f32 v156, v156, v160
    v_add_f32 v157, v157, v161
    v_add_f32 v158, v158, v162
    v_add_f32 v159, v159, v163
    v_add_f32 v132, v132, v140
    v_add_f32 v133, v133, v141
    v_add_f32 v134, v134, v142
    v_add_f32 v135, v135, v143
    v_add_f32 v148, v148, v156
    v_add_f32 v149, v149, v157
    v_add_f32 v150, v150, v158
    v_add_f32 v151, v151, v159
    v_add_f32 v132, v132, v164
    v_add_f32 v133, v133, v165
    v_add_f32 v134, v134, v166
    v_add_f32 v135, v135, v167
    v_add_f32 v44, v132, v148
    v_add_f32 v45, v133, v149
    v_add_f32 v46, v134, v150
    v_add_f32 v47, v135, v151
    s_branch L_r2_done
L_r2_useA:
    v_add_f32 v96, v96, v100
    v_add_f32 v97, v97, v101
    v_add_f32 v98, v98, v102
    v_add_f32 v99, v99, v103
    v_add_f32 v104, v104, v108
    v_add_f32 v105, v105, v109
    v_add_f32 v106, v106, v110
    v_add_f32 v107, v107, v111
    v_add_f32 v112, v112, v116
    v_add_f32 v113, v113, v117
    v_add_f32 v114, v114, v118
    v_add_f32 v115, v115, v119
    v_add_f32 v120, v120, v124
    v_add_f32 v121, v121, v125
    v_add_f32 v122, v122, v126
    v_add_f32 v123, v123, v127
    v_add_f32 v96, v96, v104
    v_add_f32 v97, v97, v105
    v_add_f32 v98, v98, v106
    v_add_f32 v99, v99, v107
    v_add_f32 v112, v112, v120
    v_add_f32 v113, v113, v121
    v_add_f32 v114, v114, v122
    v_add_f32 v115, v115, v123
    v_add_f32 v96, v96, v128
    v_add_f32 v97, v97, v129
    v_add_f32 v98, v98, v130
    v_add_f32 v99, v99, v131
    v_add_f32 v44, v96, v112
    v_add_f32 v45, v97, v113
    v_add_f32 v46, v98, v114
    v_add_f32 v47, v99, v115
L_r2_done:
    v_add_f32_dpp v44, v44, v44 row_ror:8 row_mask:0xf bank_mask:0xf
    v_add_f32_dpp v45, v45, v45 row_ror:8 row_mask:0xf bank_mask:0xf
    v_add_f32_dpp v46, v46, v46 row_ror:8 row_mask:0xf bank_mask:0xf
    v_add_f32_dpp v47, v47, v47 row_ror:8 row_mask:0xf bank_mask:0xf
    v_add_f32_dpp v44, v44, v44 row_ror:4 row_mask:0xf bank_mask:0xf
    v_add_f32_dpp v45, v45, v45 row_ror:4 row_mask:0xf bank_mask:0xf
    v_add_f32_dpp v46, v46, v46 row_ror:4 row_mask:0xf bank_mask:0xf
    v_add_f32_dpp v47, v47, v47 row_ror:4 row_mask:0xf bank_mask:0xf
    v_mov_b32 v16, v44
    v_mov_b32 v17, v45
    v_mov_b32 v18, v46
    v_mov_b32 v19, v47
    v_permlane16_swap_b32 v44, v16
    v_permlane16_swap_b32 v45, v17
    v_permlane16_swap_b32 v46, v18
    v_permlane16_swap_b32 v47, v19
    v_add_f32 v44, v44, v16
    v_add_f32 v45, v45, v17
    v_add_f32 v46, v46, v18
    v_add_f32 v47, v47, v19
    v_mov_b32 v16, v44
    v_mov_b32 v17, v45
    v_mov_b32 v18, v46
    v_mov_b32 v19, v47
    v_permlane32_swap_b32 v44, v16
    v_permlane32_swap_b32 v45, v17
    v_permlane32_swap_b32 v46, v18
    v_permlane32_swap_b32 v47, v19
    v_add_f32 v44, v44, v16
    v_add_f32 v45, v45, v17
    v_add_f32 v46, v46, v18
    v_add_f32 v47, v47, v19
    v_cvt_pk_bf16_f32 v16, v44, v45
    v_cvt_pk_bf16_f32 v17, v46, v47
    v_lshlrev_b32 v44, 16, v16
    v_and_b32 v45, 0xffff0000, v16
    v_lshlrev_b32 v46, 16, v17
    v_and_b32 v47, 0xffff0000, v17
    v_mul_f32 v44, v44, v28
    v_mul_f32 v45, v45, v29
    v_mul_f32 v46, v46, v30
    v_mul_f32 v47, v47, v31
    v_cvt_pk_bf16_f32 v16, v44, v45
    v_cvt_pk_bf16_f32 v17, v46, v47
    v_lshlrev_b32 v44, 16, v16
    v_and_b32 v45, 0xffff0000, v16
    v_lshlrev_b32 v46, 16, v17
    v_and_b32 v47, 0xffff0000, v17
    v_add_f32 v44, v44, v32
    v_add_f32 v45, v45, v33
    v_add_f32 v46, v46, v34
    v_add_f32 v47, v47, v35
    v_cvt_pk_bf16_f32 v12, v44, v45
    v_cvt_pk_bf16_f32 v13, v46, v47
    s_mov_b64 exec, 0xf
    buffer_store_dwordx2 v[12:13], v10, s[48:51], s10 offen
    s_mov_b64 exec, 1
    s_cmp_lg_u32 s69, 0
    s_cbranch_scc1 L_r_noepoch
    buffer_store_dword v14, v15, s[44:47], 0 offen sc1
L_r_noepoch:
    s_mov_b64 exec, -1
    s_endpgm
L_ct_end:
    s_endpgm
L_ct_wor:
    s_mov_b32 s71, s70
    s_lshr_b32 s6, s4, 1
    s_lshl_b32 s6, s6, 9
    s_lshl_b32 s7, s3, 6
    s_add_u32 s6, s6, s7
    s_mul_i32 s6, s6, 1152
    s_lshl_b32 s7, s71, 7
    s_add_u32 s6, s6, s7
    s_add_u32 s48, s24, s6
    s_addc_u32 s49, s25, 0
    s_mov_b32 s50, 4718592
    s_mov_b32 s51, 0x20000
    s_sub_u32 s50, s50, s6
    v_lshrrev_b32 v8, 3, v1
    v_mul_u32_u24 v8, 1152, v8
    v_and_b32 v9, 7, v1
    v_lshl_add_u32 v42, v9, 4, v8
    s_mov_b32 s43, 0
    v_mov_b32 v46, 720
L_wo_wv:
    ds_read_b32 v47, v46
    s_add_u32 s43, s43, 1
    s_cmp_lt_u32 s43, 1600000
    s_cbranch_scc0 L_wo_wv_done
    s_waitcnt lgkmcnt(0)
    v_cmp_ne_u32 vcc, 8, v47
    s_cbranch_vccz L_wo_wv_done
    s_sleep 1
    s_branch L_wo_wv
L_wo_wv_done:
    s_waitcnt lgkmcnt(0)
    s_mov_b32 s7, 0
    buffer_load_dwordx4 v[64:67], v42, s[48:51], s7 offen nt
    s_mov_b32 s7, 9216
    buffer_load_dwordx4 v[68:71], v42, s[48:51], s7 offen nt
    s_mov_b32 s7, 18432
    buffer_load_dwordx4 v[72:75], v42, s[48:51], s7 offen nt
    s_mov_b32 s7, 27648
    buffer_load_dwordx4 v[76:79], v42, s[48:51], s7 offen nt
    s_mov_b32 s7, 36864
    buffer_load_dwordx4 v[80:83], v42, s[48:51], s7 offen nt
    s_mov_b32 s7, 46080
    buffer_load_dwordx4 v[84:87], v42, s[48:51], s7 offen nt
    s_mov_b32 s7, 55296
    buffer_load_dwordx4 v[88:91], v42, s[48:51], s7 offen nt
    s_mov_b32 s7, 64512
    buffer_load_dwordx4 v[92:95], v42, s[48:51], s7 offen nt
    s_mov_b32 s7, 294912
    buffer_load_dwordx4 v[96:99], v42, s[48:51], s7 offen nt
    s_mov_b32 s7, 304128
    buffer_load_dwordx4 v[100:103], v42, s[48:51], s7 offen nt
    s_mov_b32 s7, 313344
    buffer_load_dwordx4 v[104:107], v42, s[48:51], s7 offen nt
    s_mov_b32 s7, 322560
    buffer_load_dwordx4 v[108:111], v42, s[48:51], s7 offen nt
    s_mov_b32 s7, 331776
    buffer_load_dwordx4 v[112:115], v42, s[48:51], s7 offen nt
    s_mov_b32 s7, 340992
    buffer_load_dwordx4 v[116:119], v42, s[48:51], s7 offen nt
    s_mov_b32 s7, 350208
    buffer_load_dwordx4 v[120:123], v42, s[48:51], s7 offen nt
    s_mov_b32 s7, 359424
    buffer_load_dwordx4 v[124:127], v42, s[48:51], s7 offen nt
    s_mov_b32 s43, 0
    v_mov_b32 v46, 716
L_wo_wp:
    ds_read_b32 v47, v46
    s_add_u32 s43, s43, 1
    s_cmp_lt_u32 s43, 1600000
    s_cbranch_scc0 L_wo_wp_done
    s_waitcnt lgkmcnt(0)
    v_cmp_ne_u32 vcc, 8, v47
    s_cbranch_vccz L_wo_wp_done
    s_sleep 1
    s_branch L_wo_wp
L_wo_wp_done:
    s_waitcnt lgkmcnt(0)
    v_lshrrev_b32 v8, 4, v1
    v_lshlrev_b32 v9, 10, v8
    v_and_b32 v10, 15, v1
    v_lshl_add_u32 v9, v10, 4, v9
    v_lshlrev_b32 v8, 7, v8
    s_lshr_b32 s12, s4, 1
    s_lshl_b32 s6, s12, 15
    s_lshl_b32 s7, s3, 8
    s_add_u32 s6, s6, s7
    s_add_u32 s6, s6, 131072
    s_lshl_b32 s8, s12, 12
    s_lshr_b32 s7, s3, 1
    s_lshl_b32 s7, s7, 3
    s_add_u32 s8, s8, s7
    s_add_u32 s8, s8, 393216
    s_lshl_b32 s7, s3, 9
    v_lshlrev_b32 v10, 4, v10
    v_add_u32 v10, s7, v10
    v_lshrrev_b32 v11, 3, v1
    v_lshlrev_b32 v11, 2, v11
    v_add_u32 v11, s7, v11
    s_mul_i32 s73, s12, 2304
    s_lshl_b32 s7, s71, 8
    s_add_u32 s73, s73, s7
    s_add_u32 s73, s73, 458752
    v_and_b32 v2, 7, v1
    v_lshlrev_b32 v2, 5, v2
    v_bfe_u32 v40, v1, 4, 1
    v_lshl_add_u32 v2, v40, 4, v2
    v_lshrrev_b32 v40, 5, v1
    v_lshl_add_u32 v2, v40, 3, v2
    s_lshl_b32 s7, s3, 8
    v_add_u32 v2, s7, v2
    v_lshlrev_b32 v41, 4, v1
    s_mov_b32 s43, 0
L_h1s:
    s_add_u32 s9, s8, 0
    buffer_load_dwordx2 v[128:129], v8, s[44:47], s9 offen offset:0 sc1
    buffer_load_dwordx2 v[130:131], v8, s[44:47], s9 offen offset:512 sc1
    buffer_load_dwordx2 v[132:133], v8, s[44:47], s9 offen offset:1024 sc1
    buffer_load_dwordx2 v[134:135], v8, s[44:47], s9 offen offset:1536 sc1
    s_add_u32 s9, s8, 2048
    buffer_load_dwordx2 v[136:137], v8, s[44:47], s9 offen offset:0 sc1
    buffer_load_dwordx2 v[138:139], v8, s[44:47], s9 offen offset:512 sc1
    buffer_load_dwordx2 v[140:141], v8, s[44:47], s9 offen offset:1024 sc1
    buffer_load_dwordx2 v[142:143], v8, s[44:47], s9 offen offset:1536 sc1
    s_waitcnt vmcnt(0)
    v_max3_u32 v144, v128, v129, v130
    v_max3_u32 v145, v131, v132, v133
    v_max3_u32 v144, v144, v134, v135
    v_max3_u32 v145, v145, v136, v137
    v_max3_u32 v144, v144, v138, v139
    v_max3_u32 v145, v145, v140, v141
    v_max3_u32 v144, v144, v142, v143
    v_max_u32 v144, v144, v145
    v_cmp_eq_u32 vcc, -1, v144
    s_cbranch_vccz L_h1s_done
    s_add_u32 s43, s43, 1
    s_cmp_lt_u32 s43, 200000
    s_cbranch_scc0 L_h1s_done
    s_sleep 4
    s_branch L_h1s
L_h1s_done:
    v_max3_f32 v144, v128, v130, v132
    v_max_f32 v144, v144, v134
    v_max3_f32 v145, v136, v138, v140
    v_max_f32 v145, v145, v142
    v_mov_b32 v146, v144
    v_mov_b32 v147, v145
    s_nop 0
    v_permlane16_swap_b32 v144, v146
    v_permlane16_swap_b32 v145, v147
    v_max_f32 v144, v144, v146
    v_max_f32 v145, v145, v147
    v_mov_b32 v146, v144
    v_mov_b32 v147, v145
    s_nop 0
    v_permlane32_swap_b32 v144, v146
    v_permlane32_swap_b32 v145, v147
    v_max_f32 v144, v144, v146
    v_max_f32 v145, v145, v147
    v_sub_f32 v160, v128, v144
    v_sub_f32 v161, v130, v144
    v_sub_f32 v162, v132, v144
    v_sub_f32 v163, v134, v144
    v_sub_f32 v164, v136, v145
    v_sub_f32 v165, v138, v145
    v_sub_f32 v166, v140, v145
    v_sub_f32 v167, v142, v145
    v_mul_f32 v160, s57, v160
    v_mul_f32 v161, s57, v161
    v_mul_f32 v162, s57, v162
    v_mul_f32 v163, s57, v163
    v_mul_f32 v164, s57, v164
    v_mul_f32 v165, s57, v165
    v_mul_f32 v166, s57, v166
    v_mul_f32 v167, s57, v167
    v_exp_f32 v160, v160
    v_exp_f32 v161, v161
    v_exp_f32 v162, v162
    v_exp_f32 v163, v163
    v_exp_f32 v164, v164
    v_exp_f32 v165, v165
    v_exp_f32 v166, v166
    v_exp_f32 v167, v167
    v_mul_f32 v148, v160, v129
    v_fmac_f32 v148, v161, v131
    v_fmac_f32 v148, v162, v133
    v_fmac_f32 v148, v163, v135
    v_mul_f32 v149, v164, v137
    v_fmac_f32 v149, v165, v139
    v_fmac_f32 v149, v166, v141
    v_fmac_f32 v149, v167, v143
    v_mov_b32 v146, v148
    v_mov_b32 v147, v149
    s_nop 0
    v_permlane16_swap_b32 v148, v146
    v_permlane16_swap_b32 v149, v147
    v_add_f32 v148, v148, v146
    v_add_f32 v149, v149, v147
    v_mov_b32 v146, v148
    v_mov_b32 v147, v149
    s_nop 0
    v_permlane32_swap_b32 v148, v146
    v_permlane32_swap_b32 v149, v147
    v_add_f32 v148, v148, v146
    v_add_f32 v149, v149, v147
    v_rcp_f32 v148, v148
    v_rcp_f32 v149, v149
    v_mul_f32 v160, v160, v148
    v_mul_f32 v161, v161, v148
    v_mul_f32 v162, v162, v148
    v_mul_f32 v163, v163, v148
    v_mul_f32 v164, v164, v149
    v_mul_f32 v165, v165, v149
    v_mul_f32 v166, v166, v149
    v_mul_f32 v167, v167, v149
    s_mov_b32 s43, 0
L_h1:
    s_add_u32 s9, s6, 0
    buffer_load_dwordx4 v[128:131], v9, s[44:47], s9 offen sc1
    s_add_u32 s9, s6, 4096
    buffer_load_dwordx4 v[132:135], v9, s[44:47], s9 offen sc1
    s_add_u32 s9, s6, 8192
    buffer_load_dwordx4 v[136:139], v9, s[44:47], s9 offen sc1
    s_add_u32 s9, s6, 12288
    buffer_load_dwordx4 v[140:143], v9, s[44:47], s9 offen sc1
    s_add_u32 s9, s6, 16384
    buffer_load_dwordx4 v[144:147], v9, s[44:47], s9 offen sc1
    s_add_u32 s9, s6, 20480
    buffer_load_dwordx4 v[148:151], v9, s[44:47], s9 offen sc1
    s_add_u32 s9, s6, 24576
    buffer_load_dwordx4 v[152:155], v9, s[44:47], s9 offen sc1
    s_add_u32 s9, s6, 28672
    buffer_load_dwordx4 v[156:159], v9, s[44:47], s9 offen sc1
    s_waitcnt vmcnt(0)
    v_max3_u32 v56, v128, v129, v130
    v_max3_u32 v57, v131, v132, v133
    v_max3_u32 v56, v56, v134, v135
    v_max3_u32 v57, v57, v136, v137
    v_max3_u32 v56, v56, v138, v139
    v_max3_u32 v57, v57, v140, v141
    v_max3_u32 v56, v56, v142, v143
    v_max3_u32 v57, v57, v144, v145
    v_max3_u32 v56, v56, v146, v147
    v_max3_u32 v57, v57, v148, v149
    v_max3_u32 v56, v56, v150, v151
    v_max3_u32 v57, v57, v152, v153
    v_max3_u32 v56, v56, v154, v155
    v_max3_u32 v57, v57, v156, v157
    v_max3_u32 v56, v56, v158, v159
    v_max_u32 v56, v56, v57
    v_cmp_eq_u32 vcc, -1, v56
    s_cbranch_vccz L_h1_done
    s_add_u32 s43, s43, 1
    s_cmp_lt_u32 s43, 200000
    s_cbranch_scc0 L_h1_done
    s_branch L_h1
L_h1_done:
    v_mul_f32 v48, v160, v128
    v_mul_f32 v49, v160, v129
    v_mul_f32 v50, v160, v130
    v_mul_f32 v51, v160, v131
    v_fmac_f32 v48, v161, v132
    v_fmac_f32 v49, v161, v133
    v_fmac_f32 v50, v161, v134
    v_fmac_f32 v51, v161, v135
    v_fmac_f32 v48, v162, v136
    v_fmac_f32 v49, v162, v137
    v_fmac_f32 v50, v162, v138
    v_fmac_f32 v51, v162, v139
    v_fmac_f32 v48, v163, v140
    v_fmac_f32 v49, v163, v141
    v_fmac_f32 v50, v163, v142
    v_fmac_f32 v51, v163, v143
    v_mul_f32 v52, v164, v144
    v_mul_f32 v53, v164, v145
    v_mul_f32 v54, v164, v146
    v_mul_f32 v55, v164, v147
    v_fmac_f32 v52, v165, v148
    v_fmac_f32 v53, v165, v149
    v_fmac_f32 v54, v165, v150
    v_fmac_f32 v55, v165, v151
    v_fmac_f32 v52, v166, v152
    v_fmac_f32 v53, v166, v153
    v_fmac_f32 v54, v166, v154
    v_fmac_f32 v55, v166, v155
    v_fmac_f32 v52, v167, v156
    v_fmac_f32 v53, v167, v157
    v_fmac_f32 v54, v167, v158
    v_fmac_f32 v55, v167, v159
    v_mov_b32 v56, v48
    v_mov_b32 v57, v49
    v_mov_b32 v58, v50
    v_mov_b32 v59, v51
    v_mov_b32 v60, v52
    v_mov_b32 v61, v53
    v_mov_b32 v62, v54
    v_mov_b32 v63, v55
    v_permlane16_swap_b32 v48, v56
    v_permlane16_swap_b32 v49, v57
    v_permlane16_swap_b32 v50, v58
    v_permlane16_swap_b32 v51, v59
    v_permlane16_swap_b32 v52, v60
    v_permlane16_swap_b32 v53, v61
    v_permlane16_swap_b32 v54, v62
    v_permlane16_swap_b32 v55, v63
    v_add_f32 v48, v48, v56
    v_add_f32 v49, v49, v57
    v_add_f32 v50, v50, v58
    v_add_f32 v51, v51, v59
    v_add_f32 v52, v52, v60
    v_add_f32 v53, v53, v61
    v_add_f32 v54, v54, v62
    v_add_f32 v55, v55, v63
    v_mov_b32 v56, v48
    v_mov_b32 v57, v49
    v_mov_b32 v58, v50
    v_mov_b32 v59, v51
    v_mov_b32 v60, v52
    v_mov_b32 v61, v53
    v_mov_b32 v62, v54
    v_mov_b32 v63, v55
    v_permlane32_swap_b32 v48, v56
    v_permlane32_swap_b32 v49, v57
    v_permlane32_swap_b32 v50, v58
    v_permlane32_swap_b32 v51, v59
    v_permlane32_swap_b32 v52, v60
    v_permlane32_swap_b32 v53, v61
    v_permlane32_swap_b32 v54, v62
    v_permlane32_swap_b32 v55, v63
    v_add_f32 v48, v48, v56
    v_add_f32 v49, v49, v57
    v_add_f32 v50, v50, v58
    v_add_f32 v51, v51, v59
    v_add_f32 v52, v52, v60
    v_add_f32 v53, v53, v61
    v_add_f32 v54, v54, v62
    v_add_f32 v55, v55, v63
    v_cvt_pk_bf16_f32 v48, v48, v48
    v_cvt_pk_bf16_f32 v49, v49, v49
    v_cvt_pk_bf16_f32 v50, v50, v50
    v_cvt_pk_bf16_f32 v51, v51, v51
    v_cvt_pk_bf16_f32 v52, v52, v52
    v_cvt_pk_bf16_f32 v53, v53, v53
    v_cvt_pk_bf16_f32 v54, v54, v54
    v_cvt_pk_bf16_f32 v55, v55, v55
    s_mov_b64 exec, 0xffff
    ds_write_b128 v10, v[48:51] offset:24576
    ds_write_b128 v10, v[52:55] offset:24832
    s_mov_b64 exec, -1
    s_waitcnt lgkmcnt(0)
    ds_read_b32 v128, v11 offset:24576
    ds_read_b32 v129, v11 offset:24608
    ds_read_b32 v130, v11 offset:24640
    ds_read_b32 v131, v11 offset:24672
    ds_read_b32 v132, v11 offset:24704
    ds_read_b32 v133, v11 offset:24736
    ds_read_b32 v134, v11 offset:24768
    ds_read_b32 v135, v11 offset:24800
    ds_read_b32 v136, v11 offset:24832
    ds_read_b32 v137, v11 offset:24864
    ds_read_b32 v138, v11 offset:24896
    ds_read_b32 v139, v11 offset:24928
    ds_read_b32 v140, v11 offset:24960
    ds_read_b32 v141, v11 offset:24992
    ds_read_b32 v142, v11 offset:25024
    ds_read_b32 v143, v11 offset:25056
    s_waitcnt lgkmcnt(15)
    v_and_b32 v12, v128, v4
    v_and_b32 v13, v128, v5
    v_and_b32 v14, v128, v6
    v_and_b32 v15, v128, v7
    s_waitcnt lgkmcnt(14)
    v_and_b32 v16, v129, v4
    v_and_b32 v17, v129, v5
    v_and_b32 v18, v129, v6
    v_and_b32 v19, v129, v7
    v_mfma_f32_16x16x32_bf16 v[52:55], v[12:15], v[64:67], 0
    s_waitcnt lgkmcnt(13)
    v_and_b32 v20, v130, v4
    v_and_b32 v21, v130, v5
    v_and_b32 v22, v130, v6
    v_and_b32 v23, v130, v7
    v_mfma_f32_16x16x32_bf16 v[52:55], v[16:19], v[68:71], v[52:55]
    s_waitcnt lgkmcnt(12)
    v_and_b32 v12, v131, v4
    v_and_b32 v13, v131, v5
    v_and_b32 v14, v131, v6
    v_and_b32 v15, v131, v7
    v_mfma_f32_16x16x32_bf16 v[52:55], v[20:23], v[72:75], v[52:55]
    s_waitcnt lgkmcnt(11)
    v_and_b32 v16, v132, v4
    v_and_b32 v17, v132, v5
    v_and_b32 v18, v132, v6
    v_and_b32 v19, v132, v7
    v_mfma_f32_16x16x32_bf16 v[52:55], v[12:15], v[76:79], v[52:55]
    s_waitcnt lgkmcnt(10)
    v_and_b32 v20, v133, v4
    v_and_b32 v21, v133, v5
    v_and_b32 v22, v133, v6
    v_and_b32 v23, v133, v7
    v_mfma_f32_16x16x32_bf16 v[52:55], v[16:19], v[80:83], v[52:55]
    s_waitcnt lgkmcnt(9)
    v_and_b32 v12, v134, v4
    v_and_b32 v13, v134, v5
    v_and_b32 v14, v134, v6
    v_and_b32 v15, v134, v7
    v_mfma_f32_16x16x32_bf16 v[52:55], v[20:23], v[84:87], v[52:55]
    s_waitcnt lgkmcnt(8)
    v_and_b32 v16, v135, v4
    v_and_b32 v17, v135, v5
    v_and_b32 v18, v135, v6
    v_and_b32 v19, v135, v7
    v_mfma_f32_16x16x32_bf16 v[52:55], v[12:15], v[88:91], v[52:55]
    s_waitcnt lgkmcnt(7)
    v_and_b32 v20, v136, v4
    v_and_b32 v21, v136, v5
    v_and_b32 v22, v136, v6
    v_and_b32 v23, v136, v7
    v_mfma_f32_16x16x32_bf16 v[52:55], v[16:19], v[92:95], v[52:55]
    s_waitcnt lgkmcnt(6)
    v_and_b32 v12, v137, v4
    v_and_b32 v13, v137, v5
    v_and_b32 v14, v137, v6
    v_and_b32 v15, v137, v7
    v_mfma_f32_16x16x32_bf16 v[52:55], v[20:23], v[96:99], v[52:55]
    s_waitcnt lgkmcnt(5)
    v_and_b32 v16, v138, v4
    v_and_b32 v17, v138, v5
    v_and_b32 v18, v138, v6
    v_and_b32 v19, v138, v7
    v_mfma_f32_16x16x32_bf16 v[52:55], v[12:15], v[100:103], v[52:55]
    s_waitcnt lgkmcnt(4)
    v_and_b32 v20, v139, v4
    v_and_b32 v21, v139, v5
    v_and_b32 v22, v139, v6
    v_and_b32 v23, v139, v7
    v_mfma_f32_16x16x32_bf16 v[52:55], v[16:19], v[104:107], v[52:55]
    s_waitcnt lgkmcnt(3)
    v_and_b32 v12, v140, v4
    v_and_b32 v13, v140, v5
    v_and_b32 v14, v140, v6
    v_and_b32 v15, v140, v7
    v_mfma_f32_16x16x32_bf16 v[52:55], v[20:23], v[108:111], v[52:55]
    s_waitcnt lgkmcnt(2)
    v_and_b32 v16, v141, v4
    v_and_b32 v17, v141, v5
    v_and_b32 v18, v141, v6
    v_and_b32 v19, v141, v7
    v_mfma_f32_16x16x32_bf16 v[52:55], v[12:15], v[112:115], v[52:55]
    s_waitcnt lgkmcnt(1)
    v_and_b32 v20, v142, v4
    v_and_b32 v21, v142, v5
    v_and_b32 v22, v142, v6
    v_and_b32 v23, v142, v7
    v_mfma_f32_16x16x32_bf16 v[52:55], v[16:19], v[116:119], v[52:55]
    s_waitcnt lgkmcnt(0)
    v_and_b32 v12, v143, v4
    v_and_b32 v13, v143, v5
    v_and_b32 v14, v143, v6
    v_and_b32 v15, v143, v7
    v_mfma_f32_16x16x32_bf16 v[52:55], v[20:23], v[120:123], v[52:55]
    s_nop 0
    v_mfma_f32_16x16x32_bf16 v[52:55], v[12:15], v[124:127], v[52:55]
    s_nop 7
    v_permlane32_swap_b32 v52, v54
    v_permlane32_swap_b32 v53, v55
    s_nop 0
    v_add_f32_dpp v60, v54, v52 row_ror:8 row_mask:0xf bank_mask:0xf
    v_add_f32_dpp v61, v55, v53 row_ror:8 row_mask:0xf bank_mask:0xf
    s_mov_b32 exec_lo, 0xff00ff
    s_mov_b32 exec_hi, 0xff00ff
    ds_write_b64 v2, v[60:61] offset:4352
    s_mov_b64 exec, -1
    s_waitcnt lgkmcnt(0)
    s_barrier
    s_cmp_lg_u32 s3, 0
    s_cbranch_scc1 L_h1_nopub
    s_mov_b64 exec, 0xffff
    ds_read_b128 v[12:15], v41 offset:4352
    ds_read_b128 v[16:19], v41 offset:4608
    ds_read_b128 v[20:23], v41 offset:4864
    ds_read_b128 v[44:47], v41 offset:5120
    s_waitcnt lgkmcnt(0)
    v_add_f32 v12, v12, v16
    v_add_f32 v20, v20, v44
    v_add_f32 v13, v13, v17
    v_add_f32 v21, v21, v45
    v_add_f32 v14, v14, v18
    v_add_f32 v22, v22, v46
    v_add_f32 v15, v15, v19
    v_add_f32 v23, v23, v47
    v_add_f32 v12, v12, v20
    v_add_f32 v13, v13, v21
    v_add_f32 v14, v14, v22
    v_add_f32 v15, v15, v23
    buffer_store_dwordx4 v[12:15], v41, s[44:47], s73 offen sc1
    s_mov_b64 exec, -1
L_h1_nopub:
    s_endpgm
L_ct_ffn2:
    s_lshr_b32 s58, s4, 1
    s_mul_i32 s58, s58, 18
    s_add_u32 s58, s58, s70
    s_sub_u32 s58, s58, 9
    s_and_b32 s6, s58, 1
    s_mul_i32 s6, s6, 288
    s_mul_i32 s7, s3, 72
    s_add_u32 s6, s6, s7
    s_mul_i32 s6, s6, 9216
    s_lshr_b32 s7, s58, 1
    s_lshl_b32 s7, s7, 7
    s_add_u32 s6, s6, s7
    s_add_u32 s48, s28, s6
    s_addc_u32 s49, s29, 0
    s_mov_b32 s50, 5308416
    s_mov_b32 s51, 0x20000
    s_sub_u32 s50, s50, s6
    v_lshrrev_b32 v8, 3, v1
    v_mul_u32_u24 v8, 9216, v8
    v_and_b32 v9, 7, v1
    v_lshl_add_u32 v44, v9, 4, v8
    s_mul_i32 s6, s58, 36864
    s_lshl_b32 s7, s3, 7
    s_add_u32 s6, s6, s7
    s_add_u32 s52, s30, s6
    s_addc_u32 s53, s31, 0
    s_mov_b32 s54, 5308416
    s_mov_b32 s55, 0x20000
    s_sub_u32 s54, s54, s6
    v_lshrrev_b32 v8, 3, v1
    v_mul_u32_u24 v8, 1152, v8
    v_and_b32 v9, 7, v1
    v_lshl_add_u32 v45, v9, 4, v8
    s_mul_i32 s74, s58, 2304
    s_lshl_b32 s7, s3, 8
    s_add_u32 s74, s74, s7
    s_add_u32 s74, s74, 524288
    s_mul_i32 s7, s3, 1152
    s_add_u32 s8, s7, 17408
    v_lshlrev_b32 v46, 4, v1
    s_mov_b32 s43, 0
L_cc:
    s_add_u32 s9, s8, 0
    buffer_load_dwordx4 v[64:67], v46, s[44:47], s9 offen sc1
    v_mov_b32 v68, 0
    v_mov_b32 v69, s42
    v_mov_b32 v70, 0
    v_mov_b32 v71, s42
    s_add_u32 s9, s8, 27648
    buffer_load_dwordx4 v[72:75], v46, s[44:47], s9 offen sc1
    v_mov_b32 v76, 0
    v_mov_b32 v77, s42
    v_mov_b32 v78, 0
    v_mov_b32 v79, s42
    s_add_u32 s9, s8, 4608
    buffer_load_dwordx4 v[80:83], v46, s[44:47], s9 offen sc1
    v_mov_b32 v84, 0
    v_mov_b32 v85, s42
    v_mov_b32 v86, 0
    v_mov_b32 v87, s42
    s_add_u32 s9, s8, 32256
    buffer_load_dwordx4 v[88:91], v46, s[44:47], s9 offen sc1
    v_mov_b32 v92, 0
    v_mov_b32 v93, s42
    v_mov_b32 v94, 0
    v_mov_b32 v95, s42
    s_add_u32 s9, s8, 9216
    buffer_load_dwordx4 v[96:99], v46, s[44:47], s9 offen sc1
    v_mov_b32 v100, 0
    v_mov_b32 v101, s42
    v_mov_b32 v102, 0
    v_mov_b32 v103, s42
    s_add_u32 s9, s8, 36864
    buffer_load_dwordx4 v[104:107], v46, s[44:47], s9 offen sc1
    v_mov_b32 v108, 0
    v_mov_b32 v109, s42
    v_mov_b32 v110, 0
    v_mov_b32 v111, s42
    s_mov_b64 exec, 0xff
    s_add_u32 s9, s8, 0
    buffer_load_dwordx4 v[68:71], v46, s[44:47], s9 offen offset:1024 sc1
    s_add_u32 s9, s8, 27648
    buffer_load_dwordx4 v[76:79], v46, s[44:47], s9 offen offset:1024 sc1
    s_add_u32 s9, s8, 4608
    buffer_load_dwordx4 v[84:87], v46, s[44:47], s9 offen offset:1024 sc1
    s_add_u32 s9, s8, 32256
    buffer_load_dwordx4 v[92:95], v46, s[44:47], s9 offen offset:1024 sc1
    s_add_u32 s9, s8, 9216
    buffer_load_dwordx4 v[100:103], v46, s[44:47], s9 offen offset:1024 sc1
    s_add_u32 s9, s8, 36864
    buffer_load_dwordx4 v[108:111], v46, s[44:47], s9 offen offset:1024 sc1
    s_mov_b64 exec, -1
    s_waitcnt vmcnt(0)
    v_min_u32 v112, v65, v67
    v_max_u32 v113, v65, v67
    v_min3_u32 v112, v112, v69, v71
    v_max3_u32 v113, v113, v69, v71
    v_min3_u32 v112, v112, v73, v75
    v_max3_u32 v113, v113, v73, v75
    v_min3_u32 v112, v112, v77, v79
    v_max3_u32 v113, v113, v77, v79
    v_min3_u32 v112, v112, v81, v83
    v_max3_u32 v113, v113, v81, v83
    v_min3_u32 v112, v112, v85, v87
    v_max3_u32 v113, v113, v85, v87
    v_min3_u32 v112, v112, v89, v91
    v_max3_u32 v113, v113, v89, v91
    v_min3_u32 v112, v112, v93, v95
    v_max3_u32 v113, v113, v93, v95
    v_min3_u32 v112, v112, v97, v99
    v_max3_u32 v113, v113, v97, v99
    v_min3_u32 v112, v112, v101, v103
    v_max3_u32 v113, v113, v101, v103
    v_min3_u32 v112, v112, v105, v107
    v_max3_u32 v113, v113, v105, v107
    v_min3_u32 v112, v112, v109, v111
    v_max3_u32 v113, v113, v109, v111
    v_xor_b32 v112, s42, v112
    v_xor_b32 v113, s42, v113
    v_or_b32 v112, v112, v113
    v_cmp_ne_u32 vcc, 0, v112
    s_cbranch_vccz L_cc_done
    s_add_u32 s43, s43, 1
    s_cmp_lt_u32 s43, 200000
    s_cbranch_scc0 L_cc_done
    s_sleep 4
    s_branch L_cc
L_cc_done:
    v_add_f32 v112, v64, v72
    v_add_f32 v113, v66, v74
    v_add_f32 v114, v68, v76
    v_add_f32 v115, v70, v78
    v_add_f32 v116, v80, v88
    v_add_f32 v117, v82, v90
    v_add_f32 v118, v84, v92
    v_add_f32 v119, v86, v94
    v_add_f32 v120, v96, v104
    v_add_f32 v121, v98, v106
    v_add_f32 v122, v100, v108
    v_add_f32 v123, v102, v110
    v_cvt_pk_bf16_f32 v124, v112, v113
    v_cvt_pk_bf16_f32 v125, v114, v115
    v_cvt_pk_bf16_f32 v126, v116, v117
    v_cvt_pk_bf16_f32 v127, v118, v119
    v_cvt_pk_bf16_f32 v128, v120, v121
    v_cvt_pk_bf16_f32 v129, v122, v123
    v_lshlrev_b32 v112, 16, v124
    v_and_b32 v113, 0xffff0000, v124
    v_lshlrev_b32 v114, 16, v125
    v_and_b32 v115, 0xffff0000, v125
    v_lshlrev_b32 v116, 16, v126
    v_and_b32 v117, 0xffff0000, v126
    v_lshlrev_b32 v118, 16, v127
    v_and_b32 v119, 0xffff0000, v127
    v_lshlrev_b32 v120, 16, v128
    v_and_b32 v121, 0xffff0000, v128
    v_lshlrev_b32 v122, 16, v129
    v_and_b32 v123, 0xffff0000, v129
    v_add_f32 v120, 1.0, v120
    v_add_f32 v121, 1.0, v121
    v_add_f32 v122, 1.0, v122
    v_add_f32 v123, 1.0, v123
    v_cvt_pk_bf16_f32 v124, v120, v121
    v_cvt_pk_bf16_f32 v125, v122, v123
    v_lshlrev_b32 v120, 16, v124
    v_and_b32 v121, 0xffff0000, v124
    v_lshlrev_b32 v122, 16, v125
    v_and_b32 v123, 0xffff0000, v125
    s_mul_i32 s7, s3, 576
    v_lshlrev_b32 v46, 3, v1
    v_add_u32 v46, s7, v46
    ds_write_b64 v46, v[112:113] offset:16384
    ds_write_b64 v46, v[116:117] offset:18688
    ds_write_b64 v46, v[120:121] offset:20992
    s_mov_b64 exec, 0xff
    ds_write_b64 v46, v[114:115] offset:16896
    ds_write_b64 v46, v[118:119] offset:19200
    ds_write_b64 v46, v[122:123] offset:21504
    v_mov_b32 v46, 740
    v_mov_b32 v47, 1
    s_mov_b64 exec, 1
    ds_add_u32 v46, v47
    s_mov_b64 exec, -1
    s_mov_b32 s43, 0
    v_mov_b32 v46, 720
L_ffn_wv:
    ds_read_b32 v47, v46
    s_add_u32 s43, s43, 1
    s_cmp_lt_u32 s43, 1600000
    s_cbranch_scc0 L_ffn_wv_done
    s_waitcnt lgkmcnt(0)
    v_cmp_ne_u32 vcc, 8, v47
    s_cbranch_vccz L_ffn_wv_done
    s_sleep 1
    s_branch L_ffn_wv
L_ffn_wv_done:
    s_waitcnt lgkmcnt(0)
    s_sleep 50
    s_mov_b32 s64, 0
    buffer_load_dwordx4 v[64:67], v44, s[48:51], s64 offen nt
    s_mov_b32 s64, 73728
    buffer_load_dwordx4 v[68:71], v44, s[48:51], s64 offen nt
    s_mov_b32 s64, 147456
    buffer_load_dwordx4 v[72:75], v44, s[48:51], s64 offen nt
    s_mov_b32 s64, 221184
    buffer_load_dwordx4 v[76:79], v44, s[48:51], s64 offen nt
    s_mov_b32 s64, 294912
    buffer_load_dwordx4 v[80:83], v44, s[48:51], s64 offen nt
    s_mov_b32 s64, 368640
    buffer_load_dwordx4 v[84:87], v44, s[48:51], s64 offen nt
    s_mov_b32 s64, 442368
    buffer_load_dwordx4 v[88:91], v44, s[48:51], s64 offen nt
    s_mov_b32 s64, 516096
    buffer_load_dwordx4 v[92:95], v44, s[48:51], s64 offen nt
    s_mov_b32 s64, 589824
    buffer_load_dwordx4 v[96:99], v44, s[48:51], s64 offen nt
    s_mov_b32 s64, 0
    buffer_load_dwordx4 v[100:103], v45, s[52:55], s64 offen offset:0 nt
    s_mov_b32 s64, 0
    buffer_load_dwordx4 v[116:119], v45, s[52:55], s64 offen offset:512 nt
    s_mov_b32 s64, 9216
    buffer_load_dwordx4 v[104:107], v45, s[52:55], s64 offen offset:0 nt
    s_mov_b32 s64, 9216
    buffer_load_dwordx4 v[120:123], v45, s[52:55], s64 offen offset:512 nt
    v_mov_b32 v46, 736
    v_mov_b32 v47, 1
    s_mov_b64 exec, 1
    ds_add_u32 v46, v47
    s_mov_b64 exec, -1
    s_and_b32 s75, s58, 1
    s_mul_i32 s6, s75, 1152
    s_mul_i32 s7, s3, 288
    s_add_u32 s6, s6, s7
    v_lshrrev_b32 v39, 3, v1
    v_lshlrev_b32 v39, 2, v39
    v_add_u32 v36, s6, v39
    v_add_u32 v36, 768, v36
    v_and_b32 v40, 7, v1
    v_lshlrev_b32 v40, 5, v40
    v_bfe_u32 v41, v1, 4, 1
    v_lshl_add_u32 v40, v41, 4, v40
    v_lshrrev_b32 v41, 5, v1
    v_lshl_add_u32 v40, v41, 3, v40
    s_lshl_b32 s6, s3, 8
    v_add_u32 v37, s6, v40
    v_lshlrev_b32 v38, 2, v1
    s_lshl_b32 s76, s58, 7
    s_add_u32 s76, s76, 499712
    s_xor_b32 s77, s58, 1
    s_lshl_b32 s77, s77, 7
    s_add_u32 s77, s77, 499712
    v_and_b32 v41, 31, v1
    v_lshlrev_b32 v41, 2, v41
    v_and_b32 v42, 7, v1
    v_lshlrev_b32 v42, 5, v42
    v_bfe_u32 v43, v1, 4, 1
    v_lshl_add_u32 v42, v43, 4, v42
    s_mov_b32 s43, 0
    v_mov_b32 v46, 748
L_ffn_wh:
    ds_read_b32 v47, v46
    s_add_u32 s43, s43, 1
    s_cmp_lt_u32 s43, 1600000
    s_cbranch_scc0 L_ffn_wh_done
    s_waitcnt lgkmcnt(0)
    v_cmp_ne_u32 vcc, 4, v47
    s_cbranch_vccz L_ffn_wh_done
    s_sleep 1
    s_branch L_ffn_wh
L_ffn_wh_done:
    s_waitcnt lgkmcnt(0)
    s_mov_b32 s64, 18432
    buffer_load_dwordx4 v[108:111], v45, s[52:55], s64 offen offset:0 nt
    s_mov_b32 s64, 18432
    buffer_load_dwordx4 v[124:127], v45, s[52:55], s64 offen offset:512 nt
    s_mov_b32 s64, 27648
    buffer_load_dwordx4 v[112:115], v45, s[52:55], s64 offen offset:0 nt
    s_mov_b32 s64, 27648
    buffer_load_dwordx4 v[128:131], v45, s[52:55], s64 offen offset:512 nt
    s_cmp_lg_u32 s3, 0
    s_cbranch_scc1 L_w2_no3
    s_mov_b32 s64, 0
    buffer_load_dwordx4 v[132:135], v45, s[52:55], s64 offen offset:1024 nt
    s_mov_b32 s64, 9216
    buffer_load_dwordx4 v[136:139], v45, s[52:55], s64 offen offset:1024 nt
    s_mov_b32 s64, 18432
    buffer_load_dwordx4 v[140:143], v45, s[52:55], s64 offen offset:1024 nt
    s_mov_b32 s64, 27648
    buffer_load_dwordx4 v[144:147], v45, s[52:55], s64 offen offset:1024 nt
L_w2_no3:
    s_barrier
    s_barrier
    ds_read_b32 v148, v36 offset:0
    ds_read_b32 v149, v36 offset:32
    ds_read_b32 v150, v36 offset:64
    ds_read_b32 v151, v36 offset:96
    ds_read_b32 v152, v36 offset:128
    ds_read_b32 v153, v36 offset:160
    ds_read_b32 v154, v36 offset:192
    ds_read_b32 v155, v36 offset:224
    ds_read_b32 v156, v36 offset:256
    s_waitcnt lgkmcnt(8)
    v_and_b32 v16, v148, v4
    v_and_b32 v17, v148, v5
    v_and_b32 v18, v148, v6
    v_and_b32 v19, v148, v7
    s_waitcnt vmcnt(8)
    s_waitcnt lgkmcnt(7)
    v_and_b32 v20, v149, v4
    v_and_b32 v21, v149, v5
    v_and_b32 v22, v149, v6
    v_and_b32 v23, v149, v7
    v_mfma_f32_16x16x32_bf16 v[12:15], v[16:19], v[64:67], 0
    s_waitcnt lgkmcnt(6)
    v_and_b32 v28, v150, v4
    v_and_b32 v29, v150, v5
    v_and_b32 v30, v150, v6
    v_and_b32 v31, v150, v7
    v_mfma_f32_16x16x32_bf16 v[12:15], v[20:23], v[68:71], v[12:15]
    s_waitcnt lgkmcnt(5)
    v_and_b32 v16, v151, v4
    v_and_b32 v17, v151, v5
    v_and_b32 v18, v151, v6
    v_and_b32 v19, v151, v7
    v_mfma_f32_16x16x32_bf16 v[12:15], v[28:31], v[72:75], v[12:15]
    s_waitcnt lgkmcnt(4)
    v_and_b32 v20, v152, v4
    v_and_b32 v21, v152, v5
    v_and_b32 v22, v152, v6
    v_and_b32 v23, v152, v7
    v_mfma_f32_16x16x32_bf16 v[12:15], v[16:19], v[76:79], v[12:15]
    s_waitcnt lgkmcnt(3)
    v_and_b32 v28, v153, v4
    v_and_b32 v29, v153, v5
    v_and_b32 v30, v153, v6
    v_and_b32 v31, v153, v7
    v_mfma_f32_16x16x32_bf16 v[12:15], v[20:23], v[80:83], v[12:15]
    s_waitcnt lgkmcnt(2)
    v_and_b32 v16, v154, v4
    v_and_b32 v17, v154, v5
    v_and_b32 v18, v154, v6
    v_and_b32 v19, v154, v7
    v_mfma_f32_16x16x32_bf16 v[12:15], v[28:31], v[84:87], v[12:15]
    s_waitcnt lgkmcnt(1)
    v_and_b32 v20, v155, v4
    v_and_b32 v21, v155, v5
    v_and_b32 v22, v155, v6
    v_and_b32 v23, v155, v7
    v_mfma_f32_16x16x32_bf16 v[12:15], v[16:19], v[88:91], v[12:15]
    s_waitcnt lgkmcnt(0)
    v_and_b32 v28, v156, v4
    v_and_b32 v29, v156, v5
    v_and_b32 v30, v156, v6
    v_and_b32 v31, v156, v7
    v_mfma_f32_16x16x32_bf16 v[12:15], v[20:23], v[92:95], v[12:15]
    s_nop 0
    v_mfma_f32_16x16x32_bf16 v[12:15], v[28:31], v[96:99], v[12:15]
    s_nop 7
    v_permlane32_swap_b32 v12, v14
    v_permlane32_swap_b32 v13, v15
    s_nop 0
    v_add_f32_dpp v24, v14, v12 row_ror:8 row_mask:0xf bank_mask:0xf
    v_add_f32_dpp v25, v15, v13 row_ror:8 row_mask:0xf bank_mask:0xf
    s_mov_b32 exec_lo, 0xff00ff
    s_mov_b32 exec_hi, 0xff00ff
    ds_write_b64 v37, v[24:25] offset:3072
    s_mov_b64 exec, -1
    s_waitcnt lgkmcnt(0)
    s_barrier
    s_cmp_lg_u32 s3, 0
    s_cbranch_scc1 L_g1_skip
    ds_read_b32 v16, v38 offset:3072
    ds_read_b32 v17, v38 offset:3328
    ds_read_b32 v18, v38 offset:3584
    ds_read_b32 v19, v38 offset:3840
    s_mov_b32 s66, -1
    s_mov_b32 s67, 0
    s_cmp_eq_u32 s75, 0
    s_cbranch_scc1 L_g1_k0
    s_mov_b32 s66, 0
    s_mov_b32 s67, -1
L_g1_k0:
    s_waitcnt lgkmcnt(0)
    v_add_f32 v16, v16, v17
    v_add_f32 v18, v18, v19
    v_add_f32 v16, v16, v18
    s_nop 1
    v_mov_b32_dpp v20, v16 quad_perm:[0,0,0,0] row_mask:0xf bank_mask:0xf
    v_mov_b32_dpp v21, v16 quad_perm:[1,1,1,1] row_mask:0xf bank_mask:0xf
    v_mov_b32_dpp v22, v16 quad_perm:[2,2,2,2] row_mask:0xf bank_mask:0xf
    v_mov_b32_dpp v23, v16 quad_perm:[3,3,3,3] row_mask:0xf bank_mask:0xf
    s_not_b64 s[68:69], s[66:67]
    s_and_b32 s68, s68, 0x11111111
    s_and_b32 s69, s69, 0x11111111
    s_mov_b64 exec, s[68:69]
    buffer_store_dwordx4 v[20:23], v41, s[44:47], s76 offen sc1
    s_mov_b64 exec, s[66:67]
    s_mov_b32 s43, 0
L_ux:
    buffer_load_dword v17, v41, s[44:47], s77 offen sc1
    s_waitcnt vmcnt(0)
    v_cmp_u_f32 vcc, v17, v17
    s_cbranch_vccz L_ux_done
    s_add_u32 s43, s43, 1
    s_cmp_lt_u32 s43, 200000
    s_cbranch_scc0 L_ux_done
    s_branch L_ux
L_ux_done:
    v_add_f32 v16, v16, v17
    v_cvt_pk_bf16_f32 v20, v16, v16
    v_lshlrev_b32 v16, 16, v20
    v_mul_f32 v20, 0xbfb8aa3b, v16
    v_exp_f32 v20, v20
    s_nop 0
    v_add_f32 v20, 1.0, v20
    v_rcp_f32 v20, v20
    s_nop 0
    v_mul_f32 v16, v16, v20
    v_cvt_pk_bf16_f32 v16, v16, v16
    ds_write_b32 v41, v16 offset:4096
    s_mov_b64 exec, -1
    s_waitcnt lgkmcnt(0)
L_g1_skip:
    s_barrier
    ds_read_b32 v16, v39 offset:4096
    ds_read_b32 v17, v39 offset:4128
    ds_read_b32 v18, v39 offset:4160
    ds_read_b32 v19, v39 offset:4192
    s_waitcnt lgkmcnt(3)
    v_and_b32 v64, v16, v4
    v_and_b32 v65, v16, v5
    v_and_b32 v66, v16, v6
    v_and_b32 v67, v16, v7
    s_waitcnt lgkmcnt(2)
    v_and_b32 v68, v17, v4
    v_and_b32 v69, v17, v5
    v_and_b32 v70, v17, v6
    v_and_b32 v71, v17, v7
    s_waitcnt lgkmcnt(1)
    v_and_b32 v72, v18, v4
    v_and_b32 v73, v18, v5
    v_and_b32 v74, v18, v6
    v_and_b32 v75, v18, v7
    s_waitcnt lgkmcnt(0)
    v_and_b32 v76, v19, v4
    v_and_b32 v77, v19, v5
    v_and_b32 v78, v19, v6
    v_and_b32 v79, v19, v7
    s_waitcnt vmcnt(0)
    v_mfma_f32_16x16x32_bf16 v[80:83], v[64:67], v[100:103], 0
    v_mfma_f32_16x16x32_bf16 v[84:87], v[64:67], v[116:119], 0
    v_mfma_f32_16x16x32_bf16 v[80:83], v[68:71], v[104:107], v[80:83]
    v_mfma_f32_16x16x32_bf16 v[84:87], v[68:71], v[120:123], v[84:87]
    v_mfma_f32_16x16x32_bf16 v[80:83], v[72:75], v[108:111], v[80:83]
    v_mfma_f32_16x16x32_bf16 v[84:87], v[72:75], v[124:127], v[84:87]
    v_mfma_f32_16x16x32_bf16 v[80:83], v[76:79], v[112:115], v[80:83]
    v_mfma_f32_16x16x32_bf16 v[84:87], v[76:79], v[128:131], v[84:87]
    s_cmp_lg_u32 s3, 0
    s_cbranch_scc1 L_g2_no3
    v_mfma_f32_16x16x32_bf16 v[88:91], v[64:67], v[132:135], 0
    v_mfma_f32_16x16x32_bf16 v[88:91], v[68:71], v[136:139], v[88:91]
    v_mfma_f32_16x16x32_bf16 v[88:91], v[72:75], v[140:143], v[88:91]
    v_mfma_f32_16x16x32_bf16 v[88:91], v[76:79], v[144:147], v[88:91]
    s_nop 7
    v_permlane32_swap_b32 v88, v90
    v_permlane32_swap_b32 v89, v91
    s_nop 0
    v_add_f32_dpp v100, v90, v88 row_ror:8 row_mask:0xf bank_mask:0xf
    v_add_f32_dpp v101, v91, v89 row_ror:8 row_mask:0xf bank_mask:0xf
    v_mov_b32 v102, v100
    v_mov_b32 v103, v101
    s_nop 0
    v_permlane32_swap_b32 v100, v102
    v_permlane32_swap_b32 v101, v103
    s_mov_b32 exec_lo, 0xff00ff
    s_mov_b32 exec_hi, 0x0
    buffer_store_dwordx4 v[100:103], v42, s[44:47], s74 offen offset:2048 sc1
    s_mov_b64 exec, -1
L_g2_no3:
    s_nop 7
    v_permlane32_swap_b32 v80, v82
    v_permlane32_swap_b32 v81, v83
    v_permlane32_swap_b32 v84, v86
    v_permlane32_swap_b32 v85, v87
    v_add_f32_dpp v92, v82, v80 row_ror:8 row_mask:0xf bank_mask:0xf
    v_add_f32_dpp v93, v83, v81 row_ror:8 row_mask:0xf bank_mask:0xf
    v_add_f32_dpp v96, v86, v84 row_ror:8 row_mask:0xf bank_mask:0xf
    v_add_f32_dpp v97, v87, v85 row_ror:8 row_mask:0xf bank_mask:0xf
    v_mov_b32 v94, v92
    v_mov_b32 v95, v93
    v_mov_b32 v98, v96
    v_mov_b32 v99, v97
    v_permlane32_swap_b32 v92, v94
    v_permlane32_swap_b32 v93, v95
    v_permlane32_swap_b32 v96, v98
    v_permlane32_swap_b32 v97, v99
    s_mov_b32 exec_lo, 0xff00ff
    s_mov_b32 exec_hi, 0x0
    buffer_store_dwordx4 v[92:95], v42, s[44:47], s74 offen sc1
    buffer_store_dwordx4 v[96:99], v42, s[44:47], s74 offen offset:1024 sc1
    s_mov_b64 exec, -1
    s_endpgm
L_exit:
    s_endpgm
L_code_end:
.section .rodata,"a"
.p2align 6
.amdhsa_kernel adaLN_cond__gqa_block_cached__dense_activation_silu__decode_kernel
  .amdhsa_next_free_vgpr 168
  .amdhsa_next_free_sgpr 102
  .amdhsa_accum_offset 168
  .amdhsa_group_segment_fixed_size 0
  .amdhsa_kernarg_size 104
  .amdhsa_user_sgpr_count 2
  .amdhsa_user_sgpr_kernarg_segment_ptr 1
  .amdhsa_system_sgpr_workgroup_id_x 1
  .amdhsa_float_denorm_mode_32 3
  .amdhsa_float_denorm_mode_16_64 3
.end_amdhsa_kernel
```
